```python
import torch

def _softmax(x, axis=-1):
    return torch.softmax(x, dim=axis)
def _gelu(x):
    return torch.nn.functional.gelu(x, approximate="tanh")
def _silu(x):
    return torch.nn.functional.silu(x)
def _sigmoid(x):
    return torch.sigmoid(x)
def _layernorm(x, axis=-1, eps=1e-5):
    m = x.mean(dim=axis, keepdim=True)
    v = x.var(dim=axis, keepdim=True, unbiased=False)
    return (x - m) / torch.sqrt(v + eps)
def _scatter_add(tgt, idx, src, axis=0):
    return tgt.clone().index_add_(axis, idx, src)
def _segment_sum(src, seg, n):
    out = torch.zeros((n,) + src.shape[1:], dtype=src.dtype)
    return out.index_add_(0, seg, src)
def _pad(x, pw):
    flat = tuple(v for pair in reversed(pw) for v in pair)
    return torch.nn.functional.pad(x, flat)

kernel_name = 'sequential_preLN__sliding_block_cached__mixer_token_mlp__decode'

def setup_inputs():

    _w = (lambda a: (lambda t: t.to(torch.bfloat16) if t.is_floating_point() else t)(torch.as_tensor(a)))
    def _A_setup():
        B, Sq, D = 8, 1, 448
        Hq, Hkv, Sk, Dh = 16, 8, 4096, 256
        assert Hq % Hkv == 0, (Hq, Hkv)
        return {
            "x": _w((lambda *s: torch.randn(*s, dtype=torch.bfloat16) * 0.05)(B, Sq, D)),
            "k_cache": _w((lambda *s: torch.randn(*s, dtype=torch.bfloat16) * 0.8)(B, Hkv, Sk, Dh)),
            "v_cache": _w((lambda *s: torch.randn(*s, dtype=torch.bfloat16) * 0.8)(B, Hkv, Sk, Dh)),
            "wq": _w((lambda *s: torch.randn(*s, dtype=torch.bfloat16) * 0.8)(D, Hq * Dh) * (D ** -0.5)),
            "wo": _w((lambda *s: torch.randn(*s, dtype=torch.bfloat16) * 0.8)(Hq * Dh, D) * ((Hq * Dh) ** -0.5)),
        }
    _A_in = _A_setup()

    def _B_setup():
        B, S, D, F = 8, 1, 448, 1792
        return {
            "x": _w((lambda *s: torch.randn(*s, dtype=torch.bfloat16) * 0.05)(B, S, D)),
            "w1": _w((lambda *s: torch.randn(*s, dtype=torch.bfloat16) * 0.2)(S, F) * (S ** -0.5)),
            "b1": _w((lambda *s: torch.randn(*s, dtype=torch.bfloat16) * 0.2)(F) * 0.02),
            "w2": _w((lambda *s: torch.randn(*s, dtype=torch.bfloat16) * 0.2)(F, S) * (F ** -0.5)),
            "b2": _w((lambda *s: torch.randn(*s, dtype=torch.bfloat16) * 0.2)(S) * 0.02),
        }
    _B_in = _B_setup()

    return {
        "A_x": _A_in["x"],
        "A_k_cache": _A_in["k_cache"],
        "A_v_cache": _A_in["v_cache"],
        "A_wq": _A_in["wq"],
        "A_wo": _A_in["wo"],
        "B_x": _B_in["x"],
        "B_w1": _B_in["w1"],
        "B_b1": _B_in["b1"],
        "B_w2": _B_in["w2"],
        "B_b2": _B_in["b2"],
    }

def reference(A_x, A_k_cache, A_v_cache, A_wq, A_wo, B_x, B_w1, B_b1, B_w2, B_b2):
    def _A_ref(x, k_cache, v_cache, wq, wo):
        B, Sq, D = x.shape
        Hq, Dh = 16, 256
        Hkv, Sk = k_cache.shape[1], k_cache.shape[2]
        W = min(4096, max(256, Sk // 4))
        rep = Hq // Hkv
        q = (lambda x, *d: x.permute(*d))((x @ wq).reshape(B, Sq, Hq, Dh), 0, 2, 1, 3)
        k = (lambda x, n, axis: torch.repeat_interleave(x, n, dim=axis))(k_cache[:, :, Sk - W:, :], rep, axis=1)
        v = (lambda x, n, axis: torch.repeat_interleave(x, n, dim=axis))(v_cache[:, :, Sk - W:, :], rep, axis=1)
        scores = torch.einsum("bhqd,bhkd->bhqk", q, k) * (Dh ** -0.5)
        p = _softmax(scores, axis=-1)
        o = torch.einsum("bhqk,bhkd->bhqd", p, v)
        return (lambda x, *d: x.permute(*d))(o, 0, 2, 1, 3).reshape(B, Sq, Hq * Dh) @ wo

    def _B_ref(x, w1, b1, w2, b2):
        B, S, D = x.shape
        h = _layernorm(x, axis=-1)
        u = torch.einsum("bsd,sf->bdf", h, w1) + b1
        u = _gelu(u)
        y = torch.einsum("bdf,fs->bds", u, w2) + b2
        return (lambda x, *d: x.permute(*d))(y, 0, 2, 1)

    x = A_x
    h = x + _A_ref(_layernorm(x, axis=-1), A_k_cache, A_v_cache, A_wq, A_wo)
    h2 = h + _B_ref(_layernorm(h, axis=-1), B_w1, B_b1, B_w2, B_b2)
    return h2
```

```asm
; @launch grid=(256,1,1) block=(512,1,1) lds=163840
.amdgcn_target "amdgcn-amd-amdhsa--gfx950"
.text
.p2align 10
.fill 64, 4, 0xbf810000
.globl sequential_preLN__sliding_block_cached__mixer_token_mlp__decode_kernel
.p2align 8
.type sequential_preLN__sliding_block_cached__mixer_token_mlp__decode_kernel,@function
sequential_preLN__sliding_block_cached__mixer_token_mlp__decode_kernel:
    s_load_dwordx16 s[4:19], s[0:1], 0
    s_load_dwordx2 s[44:45], s[0:1], 96
    v_readfirstlane_b32 s3, v0
    s_cmpk_ge_u32 s2, 256
    s_cbranch_scc1 L_end
    v_and_b32 v0, 63, v0
    s_and_b32 s30, s2, 7
    s_lshr_b32 s33, s2, 3
    s_lshr_b32 s31, s2, 5
    s_and_b32 s32, s33, 3
    s_lshl3_add_u32 s35, s31, s30
    s_lshl_b32 s34, s35, 21
    s_add_u32 s34, s34, 0x180000
    s_load_dwordx8 s[20:27], s[0:1], 64
    s_mov_b32 s46, 4194304
    s_mov_b32 s47, 0x20000
    s_movk_i32 s71, 0xff
    v_mov_b32 v255, 160896
    v_mov_b32 v254, 1
    s_cmp_eq_u32 s30, s31
    s_cselect_b32 s75, s32, 7
    s_cmpk_lt_u32 s3, 256
    s_cbranch_scc1 L_kwave
    s_cmpk_ge_u32 s3, 448
    s_cbranch_scc1 L_ctrl
    s_bfe_u32 s3, s3, 0x20006
    s_getpc_b64 s[52:53]
L_pc:
    s_mul_i32 s51, s33, 3
    s_add_u32 s51, s51, s3
    s_lshl_b32 s51, s51, 8
    v_lshl_add_u32 v3, v0, 7, s51
    v_min_u32 v3, L_code_end-L_pc-772, v3
    s_mov_b64 exec, 3
    global_load_dword v161, v3, s[52:53] offset:768
    s_mov_b64 exec, -1
    v_lshlrev_b32 v2, 4, v0
    v_lshl_add_u32 v2, s3, 10, v2
    s_lshl2_add_u32 s60, s35, s32
    s_lshl1_add_u32 s61, s60, 256
    s_addk_i32 s60, 1024
    s_cmp_eq_u32 s3, 1
    s_cselect_b32 s61, s60, s61
    s_lshl_b32 s60, s30, 5
    s_add_u32 s60, s60, s33
    s_addk_i32 s60, 768
    s_cmp_eq_u32 s3, 2
    s_cselect_b32 s61, s60, s61
    s_lshl_b32 s61, s61, 10
    v_lshlrev_b32 v4, 7, v0
    s_lshl_b32 s60, s3, 3
    s_lshr_b32 s60, 526352, s60
    s_lshr_b32 s51, s51, 8
    s_mul_i32 s51, s51, 5
    v_add_u32 v3, s51, v0
    v_min_u32 v3, 447, v3
    s_lshl_b32 s51, s30, 10
    v_lshl_add_u32 v3, v3, 13, s51
    s_mov_b64 exec, 31
    s_waitcnt lgkmcnt(0)
    global_load_dword v162, v3, s[10:11] offset:384
    global_load_dword v162, v3, s[10:11] offset:896
    s_bfm_b64 exec, s60, 0
    buffer_load_dword v162, v4, s[44:47], s61 offen sc1
    s_mov_b64 exec, -1
    s_load_dword s67, s[22:23], 0
    global_load_dwordx4 v[144:147], v2, s[16:17]
    global_load_dwordx4 v[148:151], v2, s[18:19]
    global_load_dwordx4 v[152:155], v2, s[20:21]
    s_barrier
    s_branch L_vwave
L_ctrl:
    s_setprio 3
    s_mov_b32 s3, 3
    v_lshl_add_u32 v3, v0, 2, v255
    v_mov_b32 v4, 0
    v_subrev_u32 v3, 128, v3
    ds_write_b32 v3, v4
    v_lshlrev_b32 v12, 4, v0
    v_lshrrev_b32 v1, 3, v0
    v_and_b32 v3, 7, v0
    v_and_b32 v4, 2, v1
    v_xor_b32 v3, v3, v4
    v_lshlrev_b32 v3, 4, v3
    v_lshl_add_u32 v248, v1, 13, v3
    v_xor_b32 v249, 64, v248
    s_and_b32 s54, s31, 3
    s_lshr_b32 s55, s31, 2
    s_lshl2_add_u32 s58, s30, s54
    s_lshl1_add_u32 s58, s58, s32
    s_lshl_b32 s58, s58, 7
    s_mul_i32 s56, s55, 1835008
    s_add_u32 s58, s58, s56
    s_movk_i32 s57, 4096
    s_movk_i32 s72, 1024
    s_lshl_b32 s73, s72, 6
    s_mov_b32 m0, 151552
    s_movk_i32 s38, 7168
    s_mov_b32 s39, 0x20000
    s_mov_b32 s42, 3670016
    s_mov_b32 s43, 0x20000
    s_mov_b32 s59, 13
    s_cmp_ge_u32 s32, 2
    s_waitcnt lgkmcnt(0)
    s_barrier
    s_load_dword s70, s[44:45], 0
    s_load_dword s67, s[22:23], 0
    s_cbranch_scc1 L_noqp
    s_mov_b64 s[36:37], s[4:5]
    s_mov_b64 s[40:41], s[10:11]
    buffer_load_dwordx4 v12, s[36:39], 0 offen offset:0 lds
    buffer_load_dwordx4 v12, s[36:39], 0 offen offset:1024 lds
    buffer_load_dwordx4 v12, s[36:39], 0 offen offset:2048 lds
    buffer_load_dwordx4 v12, s[36:39], 0 offen offset:3072 lds
    s_add_u32 m0, m0, s57
    s_nop 0
    buffer_load_dwordx4 v12, s[36:39], s57 offen offset:0 lds
    buffer_load_dwordx4 v12, s[36:39], s57 offen offset:1024 lds
    buffer_load_dwordx4 v12, s[36:39], s57 offen offset:2048 lds
    s_mov_b32 m0, 122880
    s_nop 0
L_wq1:
    buffer_load_dwordx4 v248, s[40:43], s58 offen nt lds
    s_add_u32 m0, m0, s72
    s_add_u32 s58, s58, s73
    buffer_load_dwordx4 v249, s[40:43], s58 offen nt lds
    s_add_u32 m0, m0, s72
    s_add_u32 s58, s58, s73
    s_sub_u32 s59, s59, 1
    s_cbranch_scc0 L_wq1
    s_mov_b64 exec, 1
    ds_add_u32 v255, v254 offset:24
    s_mov_b64 exec, -1
    s_branch L_ctrl2
L_kwave:
    s_lshr_b32 s3, s3, 6
    v_lshrrev_b32 v1, 5, v0
    v_xor_b32 v2, v0, v1
    v_lshlrev_b32 v240, 4, v2
    s_lshl2_add_u32 s57, s3, s32
    s_lshl_b32 s57, s57, 10
    s_add_u32 s57, s57, s34
    s_mul_i32 s52, s3, 30720
    s_mov_b32 s60, s52
    s_movk_i32 s72, 1024
    s_movk_i32 s73, 16384
    s_mov_b32 s38, 0x8000000
    s_mov_b32 s39, 0x20000
    s_setprio 2
    s_lshl3_add_u32 s54, s30, s32
    s_mul_i32 s54, s54, 57344
    s_and_b32 s48, s31, 7
    s_mov_b32 s42, 3670016
    s_mov_b32 s43, 0x20000
    v_and_b32 v2, 15, v0
    v_lshl_add_u32 v2, s3, 4, v2
    v_add_u32 v3, 8, v2
    v_and_b32 v3, 64, v3
    v_lshlrev_b32 v3, 24, v3
    v_lshl_add_u32 v2, v2, 4, v3
    v_lshrrev_b32 v1, 4, v0
    v_mul_u32_u24 v1, 7168, v1
    v_add_u32 v248, v1, v2
    v_xor_b32 v241, 32, v240
    v_xor_b32 v242, 64, v240
    v_xor_b32 v243, 96, v240
    v_xor_b32 v244, 128, v240
    v_xor_b32 v245, 160, v240
    v_xor_b32 v246, 192, v240
    v_xor_b32 v247, 224, v240
    s_lshl_b32 s53, s3, 13
    s_add_u32 s53, s53, 122880
    s_lshl_b32 s51, s3, 12
    s_add_u32 s51, s51, s34
    s_mul_i32 s55, s48, 896
    s_add_u32 s55, s55, s54
    s_waitcnt lgkmcnt(0)
    s_mov_b64 s[40:41], s[12:13]
    s_mov_b64 s[36:37], s[6:7]
    s_cmp_lt_u32 s32, 2
    s_barrier
    s_cbranch_scc1 L_kwait
L_kgo:
    buffer_load_dwordx4 v[72:75], v248, s[40:43], s55 offen
    s_add_u32 s56, s55, 28672
    buffer_load_dwordx4 v[104:107], v248, s[40:43], s56 offen
    s_add_u32 s56, s55, 229376
    buffer_load_dwordx4 v[136:139], v248, s[40:43], s56 offen
    s_cmp_lg_u32 s32, 2
    s_cbranch_scc1 L_nox
    s_add_u32 m0, s53, 0
    s_add_u32 s50, s51, 0
    s_waitcnt vmcnt(5)
    buffer_load_dwordx4 v240, s[36:39], s50 offen nt lds
    s_add_u32 m0, s53, 1024
    s_add_u32 s50, s51, 16384
    s_waitcnt vmcnt(5)
    buffer_load_dwordx4 v241, s[36:39], s50 offen nt lds
    s_add_u32 m0, s53, 2048
    s_add_u32 s50, s51, 1024
    s_waitcnt vmcnt(5)
    buffer_load_dwordx4 v242, s[36:39], s50 offen nt lds
    s_add_u32 m0, s53, 3072
    s_add_u32 s50, s51, 17408
    s_waitcnt vmcnt(5)
    buffer_load_dwordx4 v243, s[36:39], s50 offen nt lds
    s_add_u32 m0, s53, 4096
    s_add_u32 s50, s51, 2048
    s_waitcnt vmcnt(5)
    buffer_load_dwordx4 v244, s[36:39], s50 offen nt lds
    s_add_u32 m0, s53, 5120
    s_add_u32 s50, s51, 18432
    s_waitcnt vmcnt(5)
    buffer_load_dwordx4 v245, s[36:39], s50 offen nt lds
    s_add_u32 m0, s53, 6144
    s_add_u32 s50, s51, 3072
    s_waitcnt vmcnt(5)
    buffer_load_dwordx4 v246, s[36:39], s50 offen nt lds
    s_add_u32 m0, s53, 7168
    s_add_u32 s50, s51, 19456
    s_waitcnt vmcnt(5)
    buffer_load_dwordx4 v247, s[36:39], s50 offen nt lds
    s_branch L_nox
L_kwait:
    s_mov_b32 s78, 0x100000
L_spin1:
    ds_read_b32 v1, v255 offset:24
    s_waitcnt lgkmcnt(0)
    v_readfirstlane_b32 s79, v1
    s_cmp_ge_u32 s79, 1
    s_cbranch_scc1 L_spind2
    s_sleep 1
    s_sub_u32 s78, s78, 1
    s_cbranch_scc0 L_spin1
L_spind2:
    s_branch L_kgo
L_nox:
    s_add_u32 s57, s57, 0x8000
    s_mov_b32 m0, s60
    s_waitcnt vmcnt(11)
    buffer_load_dwordx4 v240, s[36:39], s57 offen nt lds
    s_add_u32 s57, s57, s73
    s_add_u32 s60, s60, s72
    s_xor_b32 s55, s48, 1
    s_mulk_i32 s55, 896
    s_add_u32 s55, s55, s54
    buffer_load_dwordx4 v[76:79], v248, s[40:43], s55 offen
    s_mov_b32 m0, s60
    s_waitcnt vmcnt(11)
    buffer_load_dwordx4 v241, s[36:39], s57 offen nt lds
    s_add_u32 s57, s57, s73
    s_add_u32 s60, s60, s72
    s_add_u32 s56, s55, 28672
    buffer_load_dwordx4 v[108:111], v248, s[40:43], s56 offen
    s_mov_b32 m0, s60
    s_waitcnt vmcnt(11)
    buffer_load_dwordx4 v242, s[36:39], s57 offen nt lds
    s_add_u32 s57, s57, s73
    s_add_u32 s60, s60, s72
    s_mov_b32 m0, s60
    s_waitcnt vmcnt(11)
    buffer_load_dwordx4 v243, s[36:39], s57 offen nt lds
    s_add_u32 s57, s57, s73
    s_add_u32 s60, s60, s72
    s_add_u32 s56, s55, 229376
    buffer_load_dwordx4 v[140:143], v248, s[40:43], s56 offen
    s_mov_b32 m0, s60
    s_waitcnt vmcnt(11)
    buffer_load_dwordx4 v244, s[36:39], s57 offen nt lds
    s_add_u32 s57, s57, s73
    s_add_u32 s60, s60, s72
    s_xor_b32 s55, s48, 2
    s_mulk_i32 s55, 896
    s_add_u32 s55, s55, s54
    buffer_load_dwordx4 v[80:83], v248, s[40:43], s55 offen
    s_mov_b32 m0, s60
    s_waitcnt vmcnt(11)
    buffer_load_dwordx4 v245, s[36:39], s57 offen nt lds
    s_add_u32 s57, s57, s73
    s_add_u32 s60, s60, s72
    s_add_u32 s56, s55, 28672
    buffer_load_dwordx4 v[112:115], v248, s[40:43], s56 offen
    s_mov_b32 m0, s60
    s_waitcnt vmcnt(11)
    buffer_load_dwordx4 v246, s[36:39], s57 offen nt lds
    s_add_u32 s57, s57, s73
    s_add_u32 s60, s60, s72
    s_mov_b32 m0, s60
    s_waitcnt vmcnt(11)
    buffer_load_dwordx4 v247, s[36:39], s57 offen nt lds
    s_add_u32 s57, s57, s73
    s_add_u32 s60, s60, s72
    s_add_u32 s56, s55, 229376
    buffer_load_dwordx4 v[144:147], v248, s[40:43], s56 offen
    s_mov_b32 m0, s60
    s_waitcnt vmcnt(11)
    buffer_load_dwordx4 v240, s[36:39], s57 offen nt lds
    s_add_u32 s57, s57, s73
    s_add_u32 s60, s60, s72
    v_lshlrev_b32 v250, 4, v0
    v_and_b32 v251, 3, v0
    v_lshlrev_b32 v251, 2, v251
    s_xor_b32 s55, s48, 3
    s_mulk_i32 s55, 896
    s_add_u32 s55, s55, s54
    buffer_load_dwordx4 v[84:87], v248, s[40:43], s55 offen
    s_mov_b32 m0, s60
    s_waitcnt vmcnt(11)
    buffer_load_dwordx4 v241, s[36:39], s57 offen nt lds
    s_add_u32 s57, s57, s73
    s_add_u32 s60, s60, s72
    s_mov_b32 m0, s60
    s_waitcnt vmcnt(11)
    buffer_load_dwordx4 v242, s[36:39], s57 offen nt lds
    s_add_u32 s57, s57, s73
    s_add_u32 s60, s60, s72
    s_add_u32 s56, s55, 28672
    buffer_load_dwordx4 v[116:119], v248, s[40:43], s56 offen
    s_mov_b32 m0, s60
    s_waitcnt vmcnt(11)
    buffer_load_dwordx4 v243, s[36:39], s57 offen nt lds
    s_add_u32 s57, s57, s73
    s_add_u32 s60, s60, s72
    s_add_u32 s56, s55, 229376
    buffer_load_dwordx4 v[148:151], v248, s[40:43], s56 offen
    s_mov_b32 m0, s60
    s_waitcnt vmcnt(11)
    buffer_load_dwordx4 v244, s[36:39], s57 offen nt lds
    s_add_u32 s57, s57, s73
    s_add_u32 s60, s60, s72
    s_xor_b32 s55, s48, 4
    s_mulk_i32 s55, 896
    s_add_u32 s55, s55, s54
    buffer_load_dwordx4 v[88:91], v248, s[40:43], s55 offen
    s_mov_b32 m0, s60
    s_waitcnt vmcnt(11)
    buffer_load_dwordx4 v245, s[36:39], s57 offen nt lds
    s_add_u32 s57, s57, s73
    s_add_u32 s60, s60, s72
    s_mov_b32 m0, s60
    s_waitcnt vmcnt(11)
    buffer_load_dwordx4 v246, s[36:39], s57 offen nt lds
    s_add_u32 s57, s57, s73
    s_add_u32 s60, s60, s72
    s_add_u32 s56, s55, 28672
    buffer_load_dwordx4 v[120:123], v248, s[40:43], s56 offen
    s_mov_b32 m0, s60
    s_waitcnt vmcnt(11)
    buffer_load_dwordx4 v247, s[36:39], s57 offen nt lds
    s_add_u32 s57, s57, s73
    s_add_u32 s60, s60, s72
    s_add_u32 s56, s55, 229376
    buffer_load_dwordx4 v[152:155], v248, s[40:43], s56 offen
    s_mov_b32 m0, s60
    s_waitcnt vmcnt(11)
    buffer_load_dwordx4 v240, s[36:39], s57 offen nt lds
    s_add_u32 s57, s57, s73
    s_add_u32 s60, s60, s72
    s_xor_b32 s55, s48, 5
    s_mulk_i32 s55, 896
    s_add_u32 s55, s55, s54
    buffer_load_dwordx4 v[92:95], v248, s[40:43], s55 offen
    s_mov_b32 m0, s60
    s_waitcnt vmcnt(11)
    buffer_load_dwordx4 v241, s[36:39], s57 offen nt lds
    s_add_u32 s57, s57, s73
    s_add_u32 s60, s60, s72
    s_mov_b32 m0, s60
    s_waitcnt vmcnt(11)
    buffer_load_dwordx4 v242, s[36:39], s57 offen nt lds
    s_add_u32 s57, s57, s73
    s_add_u32 s60, s60, s72
    s_add_u32 s56, s55, 28672
    buffer_load_dwordx4 v[124:127], v248, s[40:43], s56 offen
    s_mov_b32 m0, s60
    s_waitcnt vmcnt(11)
    buffer_load_dwordx4 v243, s[36:39], s57 offen nt lds
    s_add_u32 s57, s57, s73
    s_add_u32 s60, s60, s72
    s_add_u32 s56, s55, 229376
    buffer_load_dwordx4 v[156:159], v248, s[40:43], s56 offen
    s_mov_b32 m0, s60
    s_waitcnt vmcnt(11)
    buffer_load_dwordx4 v244, s[36:39], s57 offen nt lds
    s_add_u32 s57, s57, s73
    s_add_u32 s60, s60, s72
    s_mov_b32 m0, s60
    s_waitcnt vmcnt(11)
    buffer_load_dwordx4 v245, s[36:39], s57 offen nt lds
    s_add_u32 s57, s57, s73
    s_add_u32 s60, s60, s72
    s_xor_b32 s55, s48, 6
    s_mulk_i32 s55, 896
    s_add_u32 s55, s55, s54
    buffer_load_dwordx4 v[96:99], v248, s[40:43], s55 offen
    s_mov_b32 m0, s60
    s_waitcnt vmcnt(11)
    buffer_load_dwordx4 v246, s[36:39], s57 offen nt lds
    s_add_u32 s57, s57, s73
    s_add_u32 s60, s60, s72
    s_add_u32 s56, s55, 28672
    buffer_load_dwordx4 v[128:131], v248, s[40:43], s56 offen
    s_mov_b32 m0, s60
    s_waitcnt vmcnt(11)
    buffer_load_dwordx4 v247, s[36:39], s57 offen nt lds
    s_add_u32 s57, s57, s73
    s_add_u32 s60, s60, s72
    s_add_u32 s56, s55, 229376
    buffer_load_dwordx4 v[160:163], v248, s[40:43], s56 offen
    s_mov_b32 m0, s60
    s_waitcnt vmcnt(11)
    buffer_load_dwordx4 v240, s[36:39], s57 offen nt lds
    s_add_u32 s57, s57, s73
    s_add_u32 s60, s60, s72
    s_mov_b32 m0, s60
    s_waitcnt vmcnt(11)
    buffer_load_dwordx4 v241, s[36:39], s57 offen nt lds
    s_add_u32 s57, s57, s73
    s_add_u32 s60, s60, s72
    s_xor_b32 s55, s48, 7
    s_mulk_i32 s55, 896
    s_add_u32 s55, s55, s54
    buffer_load_dwordx4 v[100:103], v248, s[40:43], s55 offen
    s_mov_b32 m0, s60
    s_waitcnt vmcnt(11)
    buffer_load_dwordx4 v242, s[36:39], s57 offen nt lds
    s_add_u32 s57, s57, s73
    s_add_u32 s60, s60, s72
    s_add_u32 s56, s55, 28672
    buffer_load_dwordx4 v[132:135], v248, s[40:43], s56 offen
    s_mov_b32 m0, s60
    s_waitcnt vmcnt(11)
    buffer_load_dwordx4 v243, s[36:39], s57 offen nt lds
    s_add_u32 s57, s57, s73
    s_add_u32 s60, s60, s72
    s_add_u32 s56, s55, 229376
    buffer_load_dwordx4 v[164:167], v248, s[40:43], s56 offen
    s_mov_b32 m0, s60
    s_waitcnt vmcnt(11)
    buffer_load_dwordx4 v244, s[36:39], s57 offen nt lds
    s_add_u32 s57, s57, s73
    s_add_u32 s60, s60, s72
    s_cmp_lg_u32 s3, 3
    s_cbranch_scc1 L_noq
    s_lshl_b32 s58, s35, 12
    s_add_u32 s58, s58, 1048576
    s_lshl3_add_u32 s59, s30, s31
    s_lshl_b32 s59, s59, 4
    s_add_u32 s59, s59, 8192
    buffer_load_dwordx4 v[8:11], v250, s[44:47], s58 offen offset:0 sc1
    buffer_load_dwordx4 v[12:15], v250, s[44:47], s58 offen offset:1024 sc1
    buffer_load_dwordx4 v[16:19], v250, s[44:47], s58 offen offset:2048 sc1
    buffer_load_dwordx4 v[20:23], v250, s[44:47], s58 offen offset:3072 sc1
    buffer_load_dword v24, v251, s[44:47], s59 offen sc1
L_noq:
    s_mov_b32 m0, s60
    s_waitcnt vmcnt(11)
    buffer_load_dwordx4 v245, s[36:39], s57 offen nt lds
    s_mov_b64 exec, 1
    ds_add_u32 v255, v254 offset:0
    s_mov_b64 exec, -1
    s_cmp_lg_u32 s3, 3
    s_cbranch_scc1 L_qdone
    s_mov_b32 s78, 0x100000
L_spin3:
    ds_read_b32 v1, v255 offset:28
    s_waitcnt lgkmcnt(0)
    v_readfirstlane_b32 s79, v1
    s_cmp_ge_u32 s79, 1
    s_cbranch_scc1 L_spind4
    s_sleep 1
    s_sub_u32 s78, s78, 1
    s_cbranch_scc0 L_spin3
L_spind4:
    ds_read_b32 v25, v255 offset:32
    s_mov_b32 s78, 65536
    v_lshlrev_b32 v28, 3, v0
    v_add_u32 v28, 159744, v28
    s_getreg_b32 s68, hwreg(HW_REG_XCC_ID, 0, 4)
    s_lshl_b32 s68, s68, 28
    s_waitcnt lgkmcnt(0) vmcnt(1)
L_qchk:
    v_bitop3_b32 v26, v8, v9, v25 bitop3:0x7e
    v_bitop3_b32 v1, v10, v11, v25 bitop3:0x7e
    v_bitop3_b32 v27, v12, v13, v25 bitop3:0x7e
    v_or3_b32 v26, v26, v1, v27
    v_bitop3_b32 v1, v14, v15, v25 bitop3:0x7e
    v_bitop3_b32 v27, v16, v17, v25 bitop3:0x7e
    v_or3_b32 v26, v26, v1, v27
    v_bitop3_b32 v1, v18, v19, v25 bitop3:0x7e
    v_bitop3_b32 v27, v20, v21, v25 bitop3:0x7e
    v_or3_b32 v26, v26, v1, v27
    v_bitop3_b32 v26, v26, v22, v25 bitop3:0xf6
    v_bitop3_b32 v26, v26, v23, v25 bitop3:0xf6
    v_cmp_ne_u32_sdwa vcc, v26, 0 src0_sel:BYTE_0 src1_sel:DWORD
    s_cbranch_vccz L_qok
    s_mov_b64 exec, vcc
    buffer_load_dwordx4 v[8:11], v250, s[44:47], s58 offen offset:0 sc1
    buffer_load_dwordx4 v[12:15], v250, s[44:47], s58 offen offset:1024 sc1
    buffer_load_dwordx4 v[16:19], v250, s[44:47], s58 offen offset:2048 sc1
    buffer_load_dwordx4 v[20:23], v250, s[44:47], s58 offen offset:3072 sc1
    s_waitcnt vmcnt(0)
    s_sub_u32 s78, s78, 1
    s_cbranch_scc0 L_qchk
L_qok:
    s_mov_b64 exec, -1
    v_and_b32 v25, 0x0fffffff, v25
    v_or_b32 v25, s68, v25
    v_pk_add_f32 v[8:9], v[8:9], v[16:17]
    v_pk_add_f32 v[10:11], v[10:11], v[18:19]
    v_pk_add_f32 v[12:13], v[12:13], v[20:21]
    v_pk_add_f32 v[14:15], v[14:15], v[22:23]
    v_cvt_pk_bf16_f32 v8, v8, v9
    v_cvt_pk_bf16_f32 v9, v10, v11
    v_cvt_pk_bf16_f32 v10, v12, v13
    v_cvt_pk_bf16_f32 v11, v14, v15
    ds_write2st64_b64 v28, v[8:9], v[10:11] offset0:0 offset1:1
    v_cmp_ne_u32 vcc, v25, v24
    s_cmp_eq_u64 vcc, 0
    s_cselect_b32 s69, 1, 0
    v_mov_b32 v1, s69
    ds_write_b32 v255, v1 offset:36
    s_mov_b64 exec, 1
    ds_add_u32 v255, v254 offset:4
    s_mov_b64 exec, -1
L_qdone:
    v_and_b32 v1, 15, v0
    v_lshrrev_b32 v2, 4, v0
    v_xor_b32 v3, v1, v2
    v_lshlrev_b32 v3, 4, v3
    v_lshl_add_u32 v3, v1, 9, v3
    v_add_u32 v250, s53, v3
    v_xor_b32 v251, 64, v250
    v_xor_b32 v252, 128, v250
    v_xor_b32 v253, 192, v250
    v_and_b32 v3, 1, v0
    v_lshlrev_b32 v249, 9, v3
    v_lshl_add_u32 v249, v2, 4, v249
    v_add_u32 v249, 159744, v249
    v_mul_u32_u24 v3, 320, v3
    v_lshl_add_u32 v3, v2, 4, v3
    v_add_u32 v248, s52, v3
    s_lshl_b32 s58, s35, 13
    s_add_u32 s58, s58, 262144
    s_lshl_b32 s59, s3, 10
    s_add_u32 s59, s59, s58
    s_sub_u32 s61, s52, s53
    s_cmp_eq_u32 s32, 2
    s_cselect_b32 s62, 983040, 0
    s_cselect_b32 s63, 247, 7
    s_or_b32 s62, s62, 4293951487
    s_mul_i32 s66, s32, 15
    s_mov_b32 s67, 44
    s_mov_b32 s78, 0x100000
L_spin5:
    ds_read_b32 v1, v255 offset:4
    s_waitcnt lgkmcnt(0)
    v_readfirstlane_b32 s79, v1
    s_cmp_ge_u32 s79, 1
    s_cbranch_scc1 L_spind6
    s_sleep 1
    s_sub_u32 s78, s78, 1
    s_cbranch_scc0 L_spin5
L_spind6:
    ds_read_b64 v[2:3], v255 offset:32
    ds_read_b128 v[8:11], v249 offset:0
    ds_read_b128 v[12:15], v249 offset:64
    ds_read_b128 v[16:19], v249 offset:128
    ds_read_b128 v[20:23], v249 offset:192
    ds_read_b128 v[24:27], v249 offset:256
    ds_read_b128 v[28:31], v249 offset:320
    ds_read_b128 v[32:35], v249 offset:384
    ds_read_b128 v[36:39], v249 offset:448
    s_waitcnt lgkmcnt(0)
    v_readfirstlane_b32 s70, v2
    v_readfirstlane_b32 s69, v3
    s_waitcnt vmcnt(14)
    ds_read_b128 v[40:43], v250 offset:0
    ds_read_b128 v[44:47], v251 offset:0
    ds_read_b128 v[48:51], v252 offset:0
    ds_read_b128 v[52:55], v253 offset:0
    ds_read_b128 v[56:59], v250 offset:256
    ds_read_b128 v[60:63], v251 offset:256
    ds_read_b128 v[64:67], v252 offset:256
    ds_read_b128 v[68:71], v253 offset:256
    v_add_u32 v250, s61, v250
    v_add_u32 v251, s61, v251
    v_add_u32 v252, s61, v252
    v_add_u32 v253, s61, v253
    ds_read_b128 v[200:203], v250 offset:0
    ds_read_b128 v[204:207], v251 offset:0
    ds_read_b128 v[208:211], v252 offset:0
    ds_read_b128 v[212:215], v253 offset:0
    ds_read_b128 v[216:219], v250 offset:256
    ds_read_b128 v[220:223], v251 offset:256
    ds_read_b128 v[224:227], v252 offset:256
    ds_read_b128 v[228:231], v253 offset:256
    v_cmp_lt_u32 vcc, 19, v0
    v_subrev_u32 v3, 20, v0
    v_min_u32 v3, v3, v0
    v_cndmask_b32 v1, 0, 1, vcc
    v_cmp_lt_u32 vcc, 15, v3
    v_mov_b32 v249, s66
    v_lshl_add_u32 v3, v1, 8, v3
    v_mov_b32 v1, s67
    v_cndmask_b32 v249, v249, v1, vcc
    v_add_lshl_u32 v249, v249, v3, 4
    v_lshl_add_u32 v3, v0, 4, s52
    s_waitcnt lgkmcnt(15)
    v_mfma_f32_16x16x32_bf16 v[232:235], v[40:43], v[8:11], 0
    s_waitcnt lgkmcnt(14)
    v_mfma_f32_16x16x32_bf16 v[232:235], v[44:47], v[12:15], v[232:235]
    s_waitcnt lgkmcnt(13)
    v_mfma_f32_16x16x32_bf16 v[232:235], v[48:51], v[16:19], v[232:235]
    s_waitcnt lgkmcnt(12)
    v_mfma_f32_16x16x32_bf16 v[232:235], v[52:55], v[20:23], v[232:235]
    s_waitcnt lgkmcnt(11)
    v_mfma_f32_16x16x32_bf16 v[232:235], v[56:59], v[24:27], v[232:235]
    s_waitcnt lgkmcnt(10)
    v_mfma_f32_16x16x32_bf16 v[232:235], v[60:63], v[28:31], v[232:235]
    s_waitcnt lgkmcnt(9)
    v_mfma_f32_16x16x32_bf16 v[232:235], v[64:67], v[32:35], v[232:235]
    s_waitcnt lgkmcnt(8)
    v_mfma_f32_16x16x32_bf16 v[232:235], v[68:71], v[36:39], v[232:235]
    ds_read_b128 v[40:43], v250 offset:8192
    ds_read_b128 v[44:47], v251 offset:8192
    ds_read_b128 v[48:51], v252 offset:8192
    ds_read_b128 v[52:55], v253 offset:8192
    ds_read_b128 v[56:59], v250 offset:8448
    ds_read_b128 v[60:63], v251 offset:8448
    ds_read_b128 v[64:67], v252 offset:8448
    ds_read_b128 v[68:71], v253 offset:8448
    s_waitcnt lgkmcnt(15)
    v_mfma_f32_16x16x32_bf16 v[236:239], v[200:203], v[8:11], 0
    s_waitcnt lgkmcnt(14)
    v_mfma_f32_16x16x32_bf16 v[236:239], v[204:207], v[12:15], v[236:239]
    s_waitcnt lgkmcnt(13)
    v_mfma_f32_16x16x32_bf16 v[236:239], v[208:211], v[16:19], v[236:239]
    s_waitcnt lgkmcnt(12)
    v_mfma_f32_16x16x32_bf16 v[236:239], v[212:215], v[20:23], v[236:239]
    s_waitcnt lgkmcnt(11)
    v_mfma_f32_16x16x32_bf16 v[236:239], v[216:219], v[24:27], v[236:239]
    s_waitcnt lgkmcnt(10)
    v_mfma_f32_16x16x32_bf16 v[236:239], v[220:223], v[28:31], v[236:239]
    s_waitcnt lgkmcnt(9)
    v_mfma_f32_16x16x32_bf16 v[236:239], v[224:227], v[32:35], v[236:239]
    s_waitcnt lgkmcnt(8)
    v_mfma_f32_16x16x32_bf16 v[236:239], v[228:231], v[36:39], v[236:239]
    s_waitcnt vmcnt(6)
    ds_read_b128 v[200:203], v250 offset:16384
    ds_read_b128 v[204:207], v251 offset:16384
    ds_read_b128 v[208:211], v252 offset:16384
    ds_read_b128 v[212:215], v253 offset:16384
    ds_read_b128 v[216:219], v250 offset:16640
    ds_read_b128 v[220:223], v251 offset:16640
    ds_read_b128 v[224:227], v252 offset:16640
    ds_read_b128 v[228:231], v253 offset:16640
    s_waitcnt lgkmcnt(15)
    v_mfma_f32_16x16x32_bf16 v[240:243], v[40:43], v[8:11], 0
    s_waitcnt lgkmcnt(14)
    v_mfma_f32_16x16x32_bf16 v[240:243], v[44:47], v[12:15], v[240:243]
    s_waitcnt lgkmcnt(13)
    v_mfma_f32_16x16x32_bf16 v[240:243], v[48:51], v[16:19], v[240:243]
    s_waitcnt lgkmcnt(12)
    v_mfma_f32_16x16x32_bf16 v[240:243], v[52:55], v[20:23], v[240:243]
    s_waitcnt lgkmcnt(11)
    v_mfma_f32_16x16x32_bf16 v[240:243], v[56:59], v[24:27], v[240:243]
    s_waitcnt lgkmcnt(10)
    v_mfma_f32_16x16x32_bf16 v[240:243], v[60:63], v[28:31], v[240:243]
    s_waitcnt lgkmcnt(9)
    v_mfma_f32_16x16x32_bf16 v[240:243], v[64:67], v[32:35], v[240:243]
    s_waitcnt lgkmcnt(8)
    v_mfma_f32_16x16x32_bf16 v[240:243], v[68:71], v[36:39], v[240:243]
    s_waitcnt lgkmcnt(7)
    v_mfma_f32_16x16x32_bf16 v[244:247], v[200:203], v[8:11], 0
    s_waitcnt lgkmcnt(6)
    v_mfma_f32_16x16x32_bf16 v[244:247], v[204:207], v[12:15], v[244:247]
    s_waitcnt lgkmcnt(5)
    v_mfma_f32_16x16x32_bf16 v[244:247], v[208:211], v[16:19], v[244:247]
    s_waitcnt lgkmcnt(4)
    v_mfma_f32_16x16x32_bf16 v[244:247], v[212:215], v[20:23], v[244:247]
    s_waitcnt lgkmcnt(3)
    v_mfma_f32_16x16x32_bf16 v[244:247], v[216:219], v[24:27], v[244:247]
    s_waitcnt lgkmcnt(2)
    v_mfma_f32_16x16x32_bf16 v[244:247], v[220:223], v[28:31], v[244:247]
    s_waitcnt lgkmcnt(1)
    v_mfma_f32_16x16x32_bf16 v[244:247], v[224:227], v[32:35], v[244:247]
    s_waitcnt lgkmcnt(0)
    v_mfma_f32_16x16x32_bf16 v[244:247], v[228:231], v[36:39], v[244:247]
    s_waitcnt vmcnt(0)
    ds_read_b128 v[40:43], v250 offset:24576
    ds_read_b128 v[44:47], v251 offset:24576
    ds_read_b128 v[48:51], v252 offset:24576
    ds_read_b128 v[52:55], v253 offset:24576
    ds_read_b128 v[56:59], v250 offset:24832
    ds_read_b128 v[60:63], v251 offset:24832
    ds_read_b128 v[64:67], v252 offset:24832
    ds_read_b128 v[68:71], v253 offset:24832
    s_waitcnt lgkmcnt(7)
    v_mfma_f32_16x16x32_bf16 v[4:7], v[40:43], v[8:11], 0
    s_waitcnt lgkmcnt(6)
    v_mfma_f32_16x16x32_bf16 v[4:7], v[44:47], v[12:15], v[4:7]
    s_waitcnt lgkmcnt(5)
    v_mfma_f32_16x16x32_bf16 v[4:7], v[48:51], v[16:19], v[4:7]
    s_waitcnt lgkmcnt(4)
    v_mfma_f32_16x16x32_bf16 v[4:7], v[52:55], v[20:23], v[4:7]
    s_waitcnt lgkmcnt(3)
    v_mfma_f32_16x16x32_bf16 v[4:7], v[56:59], v[24:27], v[4:7]
    s_waitcnt lgkmcnt(2)
    v_mfma_f32_16x16x32_bf16 v[4:7], v[60:63], v[28:31], v[4:7]
    s_waitcnt lgkmcnt(1)
    v_mfma_f32_16x16x32_bf16 v[4:7], v[64:67], v[32:35], v[4:7]
    s_waitcnt lgkmcnt(0)
    v_mfma_f32_16x16x32_bf16 v[4:7], v[68:71], v[36:39], v[4:7]
    s_mov_b32 exec_lo, 0x00030003
    s_mov_b32 exec_hi, 0x00030003
    ds_write_b128 v248, v[232:235] offset:256
    ds_write_b128 v248, v[236:239] offset:0
    ds_write_b128 v248, v[240:243] offset:64
    ds_write_b128 v248, v[244:247] offset:128
    s_nop 1
    ds_write_b128 v248, v[4:7] offset:192
    s_mov_b64 exec, s[62:63]
    ds_read_b128 v[4:7], v3
    s_cmp_eq_u32 s69, 0
    s_waitcnt lgkmcnt(0)
    v_bfi_b32 v4, s71, v2, v4
    v_bfi_b32 v5, s71, v2, v5
    v_bfi_b32 v6, s71, v2, v6
    v_bfi_b32 v7, s71, v2, v7
    s_cbranch_scc1 L_sslow
    buffer_store_dwordx4 v[4:7], v249, s[44:47], s59 offen
    s_branch L_ssd
L_sslow:
    buffer_store_dwordx4 v[4:7], v249, s[44:47], s59 offen sc1
L_ssd:
    s_mov_b64 exec, 1
    ds_add_u32 v255, v254 offset:16
    s_mov_b64 exec, -1
    s_and_b32 s60, s48, 1
    s_mul_i32 s60, s60, 0x04040404
    s_xor_b32 s76, 0x05040100, s60
    s_xor_b32 s77, 0x07060302, s60
    v_perm_b32 v8, v76, v72, s76
    v_perm_b32 v16, v76, v72, s77
    v_perm_b32 v24, v77, v73, s76
    v_perm_b32 v32, v77, v73, s77
    v_perm_b32 v40, v78, v74, s76
    v_perm_b32 v48, v78, v74, s77
    v_perm_b32 v56, v79, v75, s76
    v_perm_b32 v64, v79, v75, s77
    v_perm_b32 v9, v84, v80, s76
    v_perm_b32 v17, v84, v80, s77
    v_perm_b32 v25, v85, v81, s76
    v_perm_b32 v33, v85, v81, s77
    v_perm_b32 v41, v86, v82, s76
    v_perm_b32 v49, v86, v82, s77
    v_perm_b32 v57, v87, v83, s76
    v_perm_b32 v65, v87, v83, s77
    v_perm_b32 v10, v92, v88, s76
    v_perm_b32 v18, v92, v88, s77
    v_perm_b32 v26, v93, v89, s76
    v_perm_b32 v34, v93, v89, s77
    v_perm_b32 v42, v94, v90, s76
    v_perm_b32 v50, v94, v90, s77
    v_perm_b32 v58, v95, v91, s76
    v_perm_b32 v66, v95, v91, s77
    v_perm_b32 v11, v100, v96, s76
    v_perm_b32 v19, v100, v96, s77
    v_perm_b32 v27, v101, v97, s76
    v_perm_b32 v35, v101, v97, s77
    v_perm_b32 v43, v102, v98, s76
    v_perm_b32 v51, v102, v98, s77
    v_perm_b32 v59, v103, v99, s76
    v_perm_b32 v67, v103, v99, s77
    v_perm_b32 v12, v108, v104, s76
    v_perm_b32 v20, v108, v104, s77
    v_perm_b32 v28, v109, v105, s76
    v_perm_b32 v36, v109, v105, s77
    v_perm_b32 v44, v110, v106, s76
    v_perm_b32 v52, v110, v106, s77
    v_perm_b32 v60, v111, v107, s76
    v_perm_b32 v68, v111, v107, s77
    v_perm_b32 v13, v116, v112, s76
    v_perm_b32 v21, v116, v112, s77
    v_perm_b32 v29, v117, v113, s76
    v_perm_b32 v37, v117, v113, s77
    v_perm_b32 v45, v118, v114, s76
    v_perm_b32 v53, v118, v114, s77
    v_perm_b32 v61, v119, v115, s76
    v_perm_b32 v69, v119, v115, s77
    v_perm_b32 v14, v124, v120, s76
    v_perm_b32 v22, v124, v120, s77
    v_perm_b32 v30, v125, v121, s76
    v_perm_b32 v38, v125, v121, s77
    v_perm_b32 v46, v126, v122, s76
    v_perm_b32 v54, v126, v122, s77
    v_perm_b32 v62, v127, v123, s76
    v_perm_b32 v70, v127, v123, s77
    v_perm_b32 v15, v132, v128, s76
    v_perm_b32 v23, v132, v128, s77
    v_perm_b32 v31, v133, v129, s76
    v_perm_b32 v39, v133, v129, s77
    v_perm_b32 v47, v134, v130, s76
    v_perm_b32 v55, v134, v130, s77
    v_perm_b32 v63, v135, v131, s76
    v_perm_b32 v71, v135, v131, s77
    v_perm_b32 v72, v140, v136, s76
    v_perm_b32 v80, v140, v136, s77
    v_perm_b32 v88, v141, v137, s76
    v_perm_b32 v96, v141, v137, s77
    v_perm_b32 v104, v142, v138, s76
    v_perm_b32 v112, v142, v138, s77
    v_perm_b32 v120, v143, v139, s76
    v_perm_b32 v128, v143, v139, s77
    v_perm_b32 v73, v148, v144, s76
    v_perm_b32 v81, v148, v144, s77
    v_perm_b32 v89, v149, v145, s76
    v_perm_b32 v97, v149, v145, s77
    v_perm_b32 v105, v150, v146, s76
    v_perm_b32 v113, v150, v146, s77
    v_perm_b32 v121, v151, v147, s76
    v_perm_b32 v129, v151, v147, s77
    v_perm_b32 v74, v156, v152, s76
    v_perm_b32 v82, v156, v152, s77
    v_perm_b32 v90, v157, v153, s76
    v_perm_b32 v98, v157, v153, s77
    v_perm_b32 v106, v158, v154, s76
    v_perm_b32 v114, v158, v154, s77
    v_perm_b32 v122, v159, v155, s76
    v_perm_b32 v130, v159, v155, s77
    v_perm_b32 v75, v164, v160, s76
    v_perm_b32 v83, v164, v160, s77
    v_perm_b32 v91, v165, v161, s76
    v_perm_b32 v99, v165, v161, s77
    v_perm_b32 v107, v166, v162, s76
    v_perm_b32 v115, v166, v162, s77
    v_perm_b32 v123, v167, v163, s76
    v_perm_b32 v131, v167, v163, s77
    s_cmp_ge_u32 s3, 2
    s_cbranch_scc1 L_k23
    v_lshlrev_b32 v2, 4, v0
    s_lshl_b32 s59, s3, 12
    s_add_u32 s59, s59, s58
    s_mov_b32 s78, 65536
    s_cmp_eq_u32 s32, 3
    s_cselect_b32 s61, 8, 4
    s_mov_b32 s78, 0x100000
L_spin7:
    ds_read_b32 v1, v255 offset:48
    s_waitcnt lgkmcnt(0)
    v_readfirstlane_b32 s79, v1
    s_cmp_ge_u32 s79, s61
    s_cbranch_scc1 L_spind8
    s_sleep 2
    s_sub_u32 s78, s78, 1
    s_cbranch_scc0 L_spin7
L_spind8:
    s_mov_b32 s78, 65536
    buffer_load_dwordx4 v[200:203], v2, s[44:47], s59 offen offset:0 sc1
    buffer_load_dwordx4 v[204:207], v2, s[44:47], s59 offen offset:1024 sc1
    buffer_load_dwordx4 v[208:211], v2, s[44:47], s59 offen offset:2048 sc1
    buffer_load_dwordx4 v[212:215], v2, s[44:47], s59 offen offset:3072 sc1
    v_mul_u32_u24 v3, 137, v0
    v_lshrrev_b32 v3, 11, v3
    v_mul_u32_u24 v4, 15, v3
    v_sub_u32 v4, v0, v4
    v_cmp_le_u32 vcc, 60, v0
    v_and_b32 v5, 3, v0
    v_lshrrev_b32 v6, 2, v0
    v_cndmask_b32 v3, v3, v5, vcc
    v_cndmask_b32 v4, v4, v6, vcc
    v_add_u32 v4, 1, v4
    v_and_b32 v4, 15, v4
    v_lshlrev_b32 v3, 4, v3
    v_lshrrev_b32 v5, 2, v4
    v_lshl_add_u32 v3, v5, 8, v3
    v_and_b32 v4, 3, v4
    v_lshl_add_u32 v3, v4, 2, v3
    s_lshl_b32 s60, s3, 6
    s_add_u32 s60, s60, 155648
    v_add_u32 v3, s60, v3
L_spoll:
    s_waitcnt vmcnt(0)
    v_bitop3_b32 v4, v200, v201, s70 bitop3:0x7e
    v_bitop3_b32 v1, v202, v203, s70 bitop3:0x7e
    v_bitop3_b32 v5, v204, v205, s70 bitop3:0x7e
    v_or3_b32 v4, v4, v1, v5
    v_bitop3_b32 v1, v206, v207, s70 bitop3:0x7e
    v_bitop3_b32 v5, v208, v209, s70 bitop3:0x7e
    v_or3_b32 v4, v4, v1, v5
    v_bitop3_b32 v1, v210, v211, s70 bitop3:0x7e
    v_bitop3_b32 v5, v212, v213, s70 bitop3:0x7e
    v_or3_b32 v4, v4, v1, v5
    v_bitop3_b32 v4, v4, v214, s70 bitop3:0xf6
    v_bitop3_b32 v4, v4, v215, s70 bitop3:0xf6
    v_cmp_ne_u32_sdwa vcc, v4, 0 src0_sel:BYTE_0 src1_sel:DWORD
    s_cbranch_vccz L_sok
    s_mov_b64 exec, vcc
    s_sleep 2
    buffer_load_dwordx4 v[200:203], v2, s[44:47], s59 offen offset:0 sc1
    buffer_load_dwordx4 v[204:207], v2, s[44:47], s59 offen offset:1024 sc1
    buffer_load_dwordx4 v[208:211], v2, s[44:47], s59 offen offset:2048 sc1
    buffer_load_dwordx4 v[212:215], v2, s[44:47], s59 offen offset:3072 sc1
    s_sub_u32 s78, s78, 1
    s_cbranch_scc0 L_spoll
    s_waitcnt vmcnt(0)
L_sok:
    s_mov_b64 exec, -1
    v_max3_f32 v4, v200, v201, v202
    v_max3_f32 v4, v4, v203, v204
    v_max3_f32 v4, v4, v205, v206
    v_max3_f32 v4, v4, v207, v208
    v_max3_f32 v4, v4, v209, v210
    v_max3_f32 v4, v4, v211, v212
    v_max3_f32 v4, v4, v213, v214
    v_max_f32 v4, v4, v215
    s_nop 1
    v_max_f32_dpp v4, v4, v4 row_ror:8 row_mask:0xf bank_mask:0xf
    s_nop 1
    v_max_f32_dpp v4, v4, v4 row_ror:4 row_mask:0xf bank_mask:0xf
    s_nop 1
    v_max_f32_dpp v4, v4, v4 row_ror:2 row_mask:0xf bank_mask:0xf
    s_nop 1
    v_max_f32_dpp v4, v4, v4 row_ror:1 row_mask:0xf bank_mask:0xf
    s_nop 1
    v_max_f32_dpp v4, v4, v4 row_bcast:15 row_mask:0xa bank_mask:0xf
    s_nop 1
    v_max_f32_dpp v4, v4, v4 row_bcast:31 row_mask:0xc bank_mask:0xf
    v_mov_b32 v5, 0x3db8aa3b
    v_readlane_b32 s60, v4, 63
    s_nop 1
    v_mul_f32 v4, s60, v5
    v_fma_f32 v200, v200, v5, -v4
    v_fma_f32 v201, v201, v5, -v4
    v_fma_f32 v202, v202, v5, -v4
    v_fma_f32 v203, v203, v5, -v4
    v_fma_f32 v204, v204, v5, -v4
    v_fma_f32 v205, v205, v5, -v4
    v_fma_f32 v206, v206, v5, -v4
    v_fma_f32 v207, v207, v5, -v4
    v_fma_f32 v208, v208, v5, -v4
    v_fma_f32 v209, v209, v5, -v4
    v_fma_f32 v210, v210, v5, -v4
    v_fma_f32 v211, v211, v5, -v4
    v_fma_f32 v212, v212, v5, -v4
    v_fma_f32 v213, v213, v5, -v4
    v_fma_f32 v214, v214, v5, -v4
    v_fma_f32 v215, v215, v5, -v4
    v_exp_f32 v200, v200
    v_exp_f32 v201, v201
    v_exp_f32 v202, v202
    v_exp_f32 v203, v203
    v_exp_f32 v204, v204
    v_exp_f32 v205, v205
    v_exp_f32 v206, v206
    v_exp_f32 v207, v207
    v_exp_f32 v208, v208
    v_exp_f32 v209, v209
    v_exp_f32 v210, v210
    v_exp_f32 v211, v211
    v_exp_f32 v212, v212
    v_exp_f32 v213, v213
    v_exp_f32 v214, v214
    v_exp_f32 v215, v215
    v_pk_add_f32 v[6:7], v[200:201], v[202:203]
    v_pk_add_f32 v[6:7], v[6:7], v[204:205]
    v_pk_add_f32 v[6:7], v[6:7], v[206:207]
    v_pk_add_f32 v[6:7], v[6:7], v[208:209]
    v_pk_add_f32 v[6:7], v[6:7], v[210:211]
    v_pk_add_f32 v[6:7], v[6:7], v[212:213]
    v_pk_add_f32 v[6:7], v[6:7], v[214:215]
    v_add_f32 v4, v6, v7
    s_nop 1
    v_add_f32_dpp v4, v4, v4 row_ror:8 row_mask:0xf bank_mask:0xf
    s_nop 1
    v_add_f32_dpp v4, v4, v4 row_ror:4 row_mask:0xf bank_mask:0xf
    s_nop 1
    v_add_f32_dpp v4, v4, v4 row_ror:2 row_mask:0xf bank_mask:0xf
    s_nop 1
    v_add_f32_dpp v4, v4, v4 row_ror:1 row_mask:0xf bank_mask:0xf
    s_nop 1
    v_add_f32_dpp v4, v4, v4 row_bcast:15 row_mask:0xa bank_mask:0xf
    s_nop 1
    v_add_f32_dpp v4, v4, v4 row_bcast:31 row_mask:0xc bank_mask:0xf
    v_rcp_f32 v4, v4
    s_nop 0
    v_readlane_b32 s60, v4, 63
    s_nop 1
    v_pk_mul_f32 v[200:201], v[200:201], s[60:61] op_sel_hi:[1,0]
    v_pk_mul_f32 v[202:203], v[202:203], s[60:61] op_sel_hi:[1,0]
    v_pk_mul_f32 v[204:205], v[204:205], s[60:61] op_sel_hi:[1,0]
    v_pk_mul_f32 v[206:207], v[206:207], s[60:61] op_sel_hi:[1,0]
    v_pk_mul_f32 v[208:209], v[208:209], s[60:61] op_sel_hi:[1,0]
    v_pk_mul_f32 v[210:211], v[210:211], s[60:61] op_sel_hi:[1,0]
    v_pk_mul_f32 v[212:213], v[212:213], s[60:61] op_sel_hi:[1,0]
    v_pk_mul_f32 v[214:215], v[214:215], s[60:61] op_sel_hi:[1,0]
    v_cvt_pk_bf16_f32 v200, v200, v202
    v_cvt_pk_bf16_f32 v201, v201, v203
    ds_write_b32 v3, v200 offset:0
    ds_write_b32 v3, v201 offset:128
    v_cvt_pk_bf16_f32 v204, v204, v206
    v_cvt_pk_bf16_f32 v205, v205, v207
    ds_write_b32 v3, v204 offset:1024
    ds_write_b32 v3, v205 offset:1152
    v_cvt_pk_bf16_f32 v208, v208, v210
    v_cvt_pk_bf16_f32 v209, v209, v211
    ds_write_b32 v3, v208 offset:2048
    ds_write_b32 v3, v209 offset:2176
    v_cvt_pk_bf16_f32 v212, v212, v214
    v_cvt_pk_bf16_f32 v213, v213, v215
    ds_write_b32 v3, v212 offset:3072
    ds_write_b32 v3, v213 offset:3200
    s_mov_b64 exec, 1
    ds_add_u32 v255, v254 offset:8
    s_mov_b64 exec, -1
    s_branch L_kjoin
L_k23:
    s_cmp_lg_u32 s75, 2
    s_cbranch_scc1 L_kjoin
    s_and_b32 s62, s3, 1
    v_lshlrev_b32 v2, 4, v0
    s_lshl_b32 s59, s62, 13
    s_add_u32 s59, s59, 32768
    s_add_u32 s60, s59, 4096
    s_lshl_b32 s62, s62, 16
    v_mul_u32_u24 v3, 12, v0
    v_add_u32 v3, s62, v3
    s_mov_b32 s78, 65536
L_tpoll:
    buffer_load_dwordx4 v[200:203], v2, s[44:47], s59 offen offset:0 sc1
    buffer_load_dwordx4 v[204:207], v2, s[44:47], s59 offen offset:1024 sc1
    buffer_load_dwordx4 v[208:211], v2, s[44:47], s59 offen offset:2048 sc1
    buffer_load_dwordx4 v[212:215], v2, s[44:47], s59 offen offset:3072 sc1
    buffer_load_dwordx4 v[216:219], v2, s[44:47], s60 offen offset:0 sc1
    buffer_load_dwordx4 v[220:223], v2, s[44:47], s60 offen offset:1024 sc1
    buffer_load_dwordx4 v[224:227], v2, s[44:47], s60 offen offset:2048 sc1
    buffer_load_dwordx4 v[228:231], v2, s[44:47], s60 offen offset:3072 sc1
    s_waitcnt vmcnt(0)
    v_bitop3_b32 v4, v203, v207, s70 bitop3:0x7e
    v_bitop3_b32 v1, v211, v215, s70 bitop3:0x7e
    v_bitop3_b32 v5, v219, v223, s70 bitop3:0x7e
    v_or3_b32 v4, v4, v1, v5
    v_bitop3_b32 v4, v4, v227, s70 bitop3:0xf6
    v_bitop3_b32 v4, v4, v231, s70 bitop3:0xf6
    v_cmp_ne_u32 vcc, 0, v4
    s_cbranch_vccz L_tok
    s_mov_b64 exec, vcc
    s_sleep 4
    s_sub_u32 s78, s78, 1
    s_cbranch_scc0 L_tpoll
L_tok:
    s_mov_b64 exec, -1
    s_mov_b32 s78, 0x100000
L_spin9:
    ds_read_b32 v1, v255 offset:16
    s_waitcnt lgkmcnt(0)
    v_readfirstlane_b32 s79, v1
    s_cmp_ge_u32 s79, 4
    s_cbranch_scc1 L_spind10
    s_sleep 1
    s_sub_u32 s78, s78, 1
    s_cbranch_scc0 L_spin9
L_spind10:
    ds_write_b32 v3, v200 offset:27648
    ds_write_b32 v3, v201 offset:27652
    ds_write_b32 v3, v202 offset:27656
    ds_write_b32 v3, v204 offset:28416
    ds_write_b32 v3, v205 offset:28420
    ds_write_b32 v3, v206 offset:28424
    ds_write_b32 v3, v208 offset:29184
    ds_write_b32 v3, v209 offset:29188
    ds_write_b32 v3, v210 offset:29192
    ds_write_b32 v3, v212 offset:29952
    ds_write_b32 v3, v213 offset:29956
    ds_write_b32 v3, v214 offset:29960
    ds_write_b32 v3, v216 offset:30720
    ds_write_b32 v3, v217 offset:30724
    ds_write_b32 v3, v218 offset:30728
    ds_write_b32 v3, v220 offset:31488
    ds_write_b32 v3, v221 offset:31492
    ds_write_b32 v3, v222 offset:31496
    ds_write_b32 v3, v224 offset:32256
    ds_write_b32 v3, v225 offset:32260
    ds_write_b32 v3, v226 offset:32264
    ds_write_b32 v3, v228 offset:33024
    ds_write_b32 v3, v229 offset:33028
    ds_write_b32 v3, v230 offset:33032
L_kjoin:
    v_and_b32 v2, 15, v0
    v_lshl_add_u32 v2, s3, 4, v2
    v_add_u32 v3, 8, v2
    v_and_b32 v3, 64, v3
    v_lshlrev_b32 v3, 24, v3
    v_lshl_add_u32 v2, v2, 4, v3
    v_lshrrev_b32 v1, 4, v0
    v_mul_u32_u24 v1, 7168, v1
    v_add_u32 v252, v1, v2
    v_bfe_u32 v2, v0, 2, 2
    v_and_b32 v3, 1, v0
    v_lshl_add_u32 v2, v2, 1, v3
    v_mul_u32_u24 v2, 144, v2
    v_and_b32 v4, 48, v0
    v_add_u32 v2, v2, v4
    v_add_u32 v2, 161024, v2
    s_bfe_u32 s60, s48, 0x10001
    v_xor_b32 v3, s60, v3
    v_mul_u32_u24 v3, 0xaaaa, v3
    v_add_u32 v253, 0x4444, v3
    v_and_b32 v3, 15, v0
    v_lshl_add_u32 v3, s3, 4, v3
    v_mul_u32_u24 v4, 37, v3
    v_lshrrev_b32 v4, 8, v4
    v_mul_u32_u24 v5, 7, v4
    v_sub_u32 v5, v3, v5
    v_lshlrev_b32 v5, 1, v5
    v_lshl_add_u32 v5, v4, 7, v5
    v_and_b32 v4, 8, v4
    v_mul_u32_u24 v4, 192, v4
    v_and_b32 v3, 48, v0
    v_lshl_add_u32 v4, v3, 1, v4
    v_add_u32 v4, v4, v5
    v_add_u32 v4, 159746, v4
    v_lshlrev_b32 v244, 4, v0
    v_add_u32 v6, 159744, v244
    s_lshl2_add_u32 s59, s35, s32
    s_lshl_b32 s59, s59, 10
    s_add_u32 s59, s59, 786432
    s_cmp_lg_u32 s3, 3
    s_cbranch_scc1 L_st4
    s_mov_b32 s78, 0x100000
L_spin11:
    ds_read_b32 v1, v255 offset:16
    s_waitcnt lgkmcnt(0)
    v_readfirstlane_b32 s79, v1
    s_cmp_ge_u32 s79, 4
    s_cbranch_scc1 L_spind12
    s_sleep 1
    s_sub_u32 s78, s78, 1
    s_cbranch_scc0 L_spin11
L_spind12:
    v_mov_b32 v7, s70
    ds_write_b16 v6, v7
L_st4:
    v_mov_b32 v136, 0
    v_mov_b32 v137, 0
    v_mov_b32 v138, 0
    v_mov_b32 v139, 0
    v_mov_b32 v140, 0
    v_mov_b32 v141, 0
    v_mov_b32 v142, 0
    v_mov_b32 v143, 0
    v_mov_b32 v144, 0
    v_mov_b32 v145, 0
    v_mov_b32 v146, 0
    v_mov_b32 v147, 0
    v_mov_b32 v148, 0
    v_mov_b32 v149, 0
    v_mov_b32 v150, 0
    v_mov_b32 v151, 0
    v_mov_b32 v152, 0
    v_mov_b32 v153, 0
    v_mov_b32 v154, 0
    v_mov_b32 v155, 0
    v_mov_b32 v156, 0
    v_mov_b32 v157, 0
    v_mov_b32 v158, 0
    v_mov_b32 v159, 0
    v_mov_b32 v160, 0
    v_mov_b32 v161, 0
    v_mov_b32 v162, 0
    v_mov_b32 v163, 0
    v_mov_b32 v164, 0
    v_mov_b32 v165, 0
    v_mov_b32 v166, 0
    v_mov_b32 v167, 0
    s_mul_i32 s65, s31, 896
    s_mul_i32 s66, s3, 112
    s_add_u32 s65, s65, s66
    v_max_u32 v247, 8, v0
    v_subrev_u32 v247, 8, v247
    v_lshl_add_u32 v247, v247, 1, s65
    v_lshrrev_b32 v240, 3, v0
    v_lshlrev_b32 v240, 10, v240
    v_and_b32 v241, 7, v0
    v_lshl_add_u32 v240, v241, 4, v240
    v_add_u32 v241, 0x2000, v240
    v_add_u32 v242, 0x4000, v240
    v_add_u32 v243, 0x6000, v240
    s_cmp_lg_u32 s75, 2
    s_cbranch_scc1 L_kprep
    global_load_ushort v248, v247, s[4:5]
    s_lshl_b32 s64, s31, 8
    s_add_u32 s64, s64, s3
    s_lshl_b32 s64, s64, 7
    s_add_u32 s64, s64, 786432
    s_lshl_b32 s66, s3, 3
    v_mov_b32 v246, 0
    v_add_u32 v245, s66, v246
    v_mov_b32 v249, 0x00003f80
    v_mov_b32 v250, 0x3f800000
L_kprep:
    s_mov_b32 s78, 0x100000
L_spin13:
    ds_read_b32 v1, v255 offset:44
    s_waitcnt lgkmcnt(0)
    v_readfirstlane_b32 s79, v1
    s_cmp_ge_u32 s79, 4
    s_cbranch_scc1 L_spind14
    s_sleep 1
    s_sub_u32 s78, s78, 1
    s_cbranch_scc0 L_spin13
L_spind14:
    s_xor_b32 s55, s48, 0
    s_mulk_i32 s55, 896
    s_add_u32 s55, s55, s54
    s_add_u32 s56, s55, 258048
    buffer_load_dwordx4 v[200:203], v252, s[40:43], s56 offen
    s_xor_b32 s55, s48, 1
    s_mulk_i32 s55, 896
    s_add_u32 s55, s55, s54
    s_add_u32 s56, s55, 258048
    buffer_load_dwordx4 v[204:207], v252, s[40:43], s56 offen
    s_xor_b32 s55, s48, 2
    s_mulk_i32 s55, 896
    s_add_u32 s55, s55, s54
    s_add_u32 s56, s55, 258048
    buffer_load_dwordx4 v[208:211], v252, s[40:43], s56 offen
    s_xor_b32 s55, s48, 3
    s_mulk_i32 s55, 896
    s_add_u32 s55, s55, s54
    s_add_u32 s56, s55, 258048
    buffer_load_dwordx4 v[212:215], v252, s[40:43], s56 offen
    s_xor_b32 s55, s48, 4
    s_mulk_i32 s55, 896
    s_add_u32 s55, s55, s54
    s_add_u32 s56, s55, 258048
    buffer_load_dwordx4 v[216:219], v252, s[40:43], s56 offen
    s_xor_b32 s55, s48, 5
    s_mulk_i32 s55, 896
    s_add_u32 s55, s55, s54
    s_add_u32 s56, s55, 258048
    buffer_load_dwordx4 v[220:223], v252, s[40:43], s56 offen
    s_xor_b32 s55, s48, 6
    s_mulk_i32 s55, 896
    s_add_u32 s55, s55, s54
    s_add_u32 s56, s55, 258048
    buffer_load_dwordx4 v[224:227], v252, s[40:43], s56 offen
    s_xor_b32 s55, s48, 7
    s_mulk_i32 s55, 896
    s_add_u32 s55, s55, s54
    s_add_u32 s56, s55, 258048
    buffer_load_dwordx4 v[228:231], v252, s[40:43], s56 offen
    s_waitcnt vmcnt(6)
    v_perm_b32 v76, v204, v200, s76
    v_perm_b32 v84, v204, v200, s77
    v_perm_b32 v92, v205, v201, s76
    v_perm_b32 v100, v205, v201, s77
    v_perm_b32 v108, v206, v202, s76
    v_perm_b32 v116, v206, v202, s77
    v_perm_b32 v124, v207, v203, s76
    v_perm_b32 v132, v207, v203, s77
    s_waitcnt vmcnt(4)
    v_perm_b32 v77, v212, v208, s76
    v_perm_b32 v85, v212, v208, s77
    v_perm_b32 v93, v213, v209, s76
    v_perm_b32 v101, v213, v209, s77
    v_perm_b32 v109, v214, v210, s76
    v_perm_b32 v117, v214, v210, s77
    v_perm_b32 v125, v215, v211, s76
    v_perm_b32 v133, v215, v211, s77
    s_barrier
    ds_read_b128 v[232:235], v2
    ds_read_b128 v[236:239], v2 offset:64
    s_waitcnt vmcnt(2)
    v_perm_b32 v78, v220, v216, s76
    v_perm_b32 v86, v220, v216, s77
    v_perm_b32 v94, v221, v217, s76
    v_perm_b32 v102, v221, v217, s77
    v_perm_b32 v110, v222, v218, s76
    v_perm_b32 v118, v222, v218, s77
    v_perm_b32 v126, v223, v219, s76
    v_perm_b32 v134, v223, v219, s77
    s_waitcnt lgkmcnt(1)
    v_smfmac_f32_16x16x64_bf16 v[136:139], v[232:235], v[8:15], v253
    v_smfmac_f32_16x16x64_bf16 v[140:143], v[232:235], v[16:23], v253
    v_smfmac_f32_16x16x64_bf16 v[144:147], v[232:235], v[24:31], v253
    v_smfmac_f32_16x16x64_bf16 v[148:151], v[232:235], v[32:39], v253
    v_smfmac_f32_16x16x64_bf16 v[152:155], v[232:235], v[40:47], v253
    v_smfmac_f32_16x16x64_bf16 v[156:159], v[232:235], v[48:55], v253
    v_smfmac_f32_16x16x64_bf16 v[160:163], v[232:235], v[56:63], v253
    v_smfmac_f32_16x16x64_bf16 v[164:167], v[232:235], v[64:71], v253
    s_waitcnt vmcnt(0)
    v_perm_b32 v79, v228, v224, s76
    v_perm_b32 v87, v228, v224, s77
    v_perm_b32 v95, v229, v225, s76
    v_perm_b32 v103, v229, v225, s77
    v_perm_b32 v111, v230, v226, s76
    v_perm_b32 v119, v230, v226, s77
    v_perm_b32 v127, v231, v227, s76
    v_perm_b32 v135, v231, v227, s77
    s_waitcnt lgkmcnt(0)
    v_smfmac_f32_16x16x64_bf16 v[136:139], v[236:239], v[72:79], v253
    v_smfmac_f32_16x16x64_bf16 v[140:143], v[236:239], v[80:87], v253
    v_smfmac_f32_16x16x64_bf16 v[144:147], v[236:239], v[88:95], v253
    v_smfmac_f32_16x16x64_bf16 v[148:151], v[236:239], v[96:103], v253
    v_smfmac_f32_16x16x64_bf16 v[152:155], v[236:239], v[104:111], v253
    v_smfmac_f32_16x16x64_bf16 v[156:159], v[236:239], v[112:119], v253
    v_smfmac_f32_16x16x64_bf16 v[160:163], v[236:239], v[120:127], v253
    v_smfmac_f32_16x16x64_bf16 v[164:167], v[236:239], v[128:135], v253
    s_nop 0
    v_add_f32 v168, v136, v137
    v_add_f32 v169, v140, v141
    v_add_f32 v170, v144, v145
    v_add_f32 v171, v148, v149
    v_add_f32 v172, v152, v153
    v_add_f32 v173, v156, v157
    v_add_f32 v174, v160, v161
    v_add_f32 v175, v164, v165
    v_permlane32_swap_b32 v168, v172
    v_permlane32_swap_b32 v169, v173
    v_permlane32_swap_b32 v170, v174
    v_permlane32_swap_b32 v171, v175
    v_pk_add_f32 v[168:169], v[168:169], v[172:173]
    v_pk_add_f32 v[170:171], v[170:171], v[174:175]
    s_nop 1
    v_permlane16_swap_b32 v168, v170
    v_permlane16_swap_b32 v169, v171
    v_pk_add_f32 v[168:169], v[168:169], v[170:171]
    v_cvt_pk_bf16_f32 v168, v168, v169
    ds_write_b16 v4, v168
    ds_write_b16_d16_hi v4, v168 offset:16
    s_mov_b64 exec, 1
    ds_add_rtn_u32 v7, v255, v254 offset:40
    s_mov_b64 exec, -1
    ds_read_b128 v[208:211], v6
    s_waitcnt lgkmcnt(1)
    v_readfirstlane_b32 s60, v7
    s_cmp_lg_u32 s60, 3
    s_cbranch_scc1 L_knost
    s_waitcnt lgkmcnt(0)
    buffer_store_dwordx4 v[208:211], v244, s[44:47], s59 offen sc1
L_knost:
    s_cmp_eq_u32 s75, 2
    s_cbranch_scc1 L_gather
    s_branch L_fin
L_vwave:
    s_and_b32 s60, s2, 127
    s_mul_i32 s60, s60, 24
    s_add_u32 s60, s60, 13824
    s_lshr_b32 s61, s2, 7
    s_lshl_b32 s61, s61, 15
    s_add_u32 s60, s60, s61
    s_lshl_b32 s60, s60, 16
    s_add_u32 s61, s60, 786432
    v_mov_b32 v38, 0xbdd2d3e8
    v_mov_b32 v39, 0xc0135761
    v_and_b32 v4, 15, v0
    v_mov_b32 v104, 0
    v_mov_b32 v105, 0
    v_mov_b32 v106, 0
    v_mov_b32 v107, 0
    v_mov_b32 v108, 0
    v_mov_b32 v109, 0
    v_mov_b32 v110, 0
    v_mov_b32 v111, 0
    s_mov_b32 s62, 0
    s_waitcnt vmcnt(0)
    v_lshlrev_b32 v8, 16, v144
    v_and_b32 v9, 0xffff0000, v144
    v_lshlrev_b32 v10, 16, v145
    v_and_b32 v11, 0xffff0000, v145
    v_lshlrev_b32 v12, 16, v146
    v_and_b32 v13, 0xffff0000, v146
    v_lshlrev_b32 v14, 16, v147
    v_and_b32 v15, 0xffff0000, v147
    v_lshlrev_b32 v18, 16, v148
    v_and_b32 v19, 0xffff0000, v148
    v_lshlrev_b32 v20, 16, v149
    v_and_b32 v21, 0xffff0000, v149
    v_lshlrev_b32 v22, 16, v150
    v_and_b32 v23, 0xffff0000, v150
    v_lshlrev_b32 v24, 16, v151
    v_and_b32 v25, 0xffff0000, v151
    v_lshlrev_b32 v28, 16, v152
    v_and_b32 v29, 0xffff0000, v152
    v_lshlrev_b32 v30, 16, v153
    v_and_b32 v31, 0xffff0000, v153
    v_lshlrev_b32 v32, 16, v154
    v_and_b32 v33, 0xffff0000, v154
    v_lshlrev_b32 v34, 16, v155
    v_and_b32 v35, 0xffff0000, v155
.p2align 3
L_tloopa:
    v_cmp_eq_u32_e64 vcc, s62, v4
    v_pk_fma_f32 v[62:63], v[8:9], s[60:61], v[18:19] op_sel:[0,0,0] op_sel_hi:[1,0,1]
    v_pk_fma_f32 v[64:65], v[8:9], s[60:61], v[18:19] op_sel:[0,1,0] op_sel_hi:[1,1,1]
    v_pk_fma_f32 v[66:67], v[10:11], s[60:61], v[20:21] op_sel:[0,0,0] op_sel_hi:[1,0,1]
    v_pk_fma_f32 v[68:69], v[10:11], s[60:61], v[20:21] op_sel:[0,1,0] op_sel_hi:[1,1,1]
    v_pk_fma_f32 v[70:71], v[12:13], s[60:61], v[22:23] op_sel:[0,0,0] op_sel_hi:[1,0,1]
    v_pk_fma_f32 v[72:73], v[12:13], s[60:61], v[22:23] op_sel:[0,1,0] op_sel_hi:[1,1,1]
    v_pk_fma_f32 v[74:75], v[14:15], s[60:61], v[24:25] op_sel:[0,0,0] op_sel_hi:[1,0,1]
    v_pk_fma_f32 v[76:77], v[14:15], s[60:61], v[24:25] op_sel:[0,1,0] op_sel_hi:[1,1,1]
    v_cndmask_b32 v5, 0, 1.0, vcc
    v_pk_mul_f32 v[82:83], v[62:63], v[62:63]
    v_pk_mul_f32 v[84:85], v[64:65], v[64:65]
    v_pk_mul_f32 v[86:87], v[66:67], v[66:67]
    v_pk_mul_f32 v[88:89], v[68:69], v[68:69]
    v_pk_mul_f32 v[90:91], v[70:71], v[70:71]
    v_pk_mul_f32 v[92:93], v[72:73], v[72:73]
    v_pk_mul_f32 v[94:95], v[74:75], v[74:75]
    v_pk_mul_f32 v[96:97], v[76:77], v[76:77]
    v_pk_fma_f32 v[82:83], v[82:83], v[38:39], v[38:39] op_sel:[0,0,1] op_sel_hi:[1,0,1]
    v_pk_fma_f32 v[84:85], v[84:85], v[38:39], v[38:39] op_sel:[0,0,1] op_sel_hi:[1,0,1]
    v_pk_fma_f32 v[86:87], v[86:87], v[38:39], v[38:39] op_sel:[0,0,1] op_sel_hi:[1,0,1]
    v_pk_fma_f32 v[88:89], v[88:89], v[38:39], v[38:39] op_sel:[0,0,1] op_sel_hi:[1,0,1]
    v_pk_fma_f32 v[90:91], v[90:91], v[38:39], v[38:39] op_sel:[0,0,1] op_sel_hi:[1,0,1]
    v_pk_fma_f32 v[92:93], v[92:93], v[38:39], v[38:39] op_sel:[0,0,1] op_sel_hi:[1,0,1]
    v_pk_fma_f32 v[94:95], v[94:95], v[38:39], v[38:39] op_sel:[0,0,1] op_sel_hi:[1,0,1]
    v_pk_fma_f32 v[96:97], v[96:97], v[38:39], v[38:39] op_sel:[0,0,1] op_sel_hi:[1,0,1]
    v_pk_mul_f32 v[82:83], v[82:83], v[62:63]
    v_pk_mul_f32 v[84:85], v[84:85], v[64:65]
    v_pk_mul_f32 v[86:87], v[86:87], v[66:67]
    v_pk_mul_f32 v[88:89], v[88:89], v[68:69]
    v_pk_mul_f32 v[90:91], v[90:91], v[70:71]
    v_pk_mul_f32 v[92:93], v[92:93], v[72:73]
    v_pk_mul_f32 v[94:95], v[94:95], v[74:75]
    v_pk_mul_f32 v[96:97], v[96:97], v[76:77]
    v_exp_f32 v82, v82
    v_exp_f32 v83, v83
    v_exp_f32 v84, v84
    v_exp_f32 v85, v85
    v_exp_f32 v86, v86
    v_exp_f32 v87, v87
    v_exp_f32 v88, v88
    v_exp_f32 v89, v89
    v_exp_f32 v90, v90
    v_exp_f32 v91, v91
    v_exp_f32 v92, v92
    v_exp_f32 v93, v93
    v_exp_f32 v94, v94
    v_exp_f32 v95, v95
    v_exp_f32 v96, v96
    v_exp_f32 v97, v97
    v_pk_mul_f32 v[62:63], v[62:63], v[28:29]
    v_pk_mul_f32 v[64:65], v[64:65], v[28:29]
    v_pk_mul_f32 v[66:67], v[66:67], v[30:31]
    v_pk_mul_f32 v[68:69], v[68:69], v[30:31]
    v_pk_mul_f32 v[70:71], v[70:71], v[32:33]
    v_pk_mul_f32 v[72:73], v[72:73], v[32:33]
    v_pk_mul_f32 v[74:75], v[74:75], v[34:35]
    v_pk_mul_f32 v[76:77], v[76:77], v[34:35]
    v_pk_add_f32 v[82:83], v[82:83], 1.0 op_sel_hi:[1,0]
    v_pk_add_f32 v[84:85], v[84:85], 1.0 op_sel_hi:[1,0]
    v_pk_add_f32 v[86:87], v[86:87], 1.0 op_sel_hi:[1,0]
    v_pk_add_f32 v[88:89], v[88:89], 1.0 op_sel_hi:[1,0]
    v_pk_add_f32 v[90:91], v[90:91], 1.0 op_sel_hi:[1,0]
    v_pk_add_f32 v[92:93], v[92:93], 1.0 op_sel_hi:[1,0]
    v_pk_add_f32 v[94:95], v[94:95], 1.0 op_sel_hi:[1,0]
    v_pk_add_f32 v[96:97], v[96:97], 1.0 op_sel_hi:[1,0]
    v_rcp_f32 v82, v82
    v_rcp_f32 v83, v83
    v_rcp_f32 v84, v84
    v_rcp_f32 v85, v85
    v_rcp_f32 v86, v86
    v_rcp_f32 v87, v87
    v_rcp_f32 v88, v88
    v_rcp_f32 v89, v89
    v_rcp_f32 v90, v90
    v_rcp_f32 v91, v91
    v_rcp_f32 v92, v92
    v_rcp_f32 v93, v93
    v_rcp_f32 v94, v94
    v_rcp_f32 v95, v95
    v_rcp_f32 v96, v96
    v_rcp_f32 v97, v97
    v_pk_mul_f32 v[112:113], v[62:63], v[82:83]
    v_pk_mul_f32 v[114:115], v[64:65], v[84:85]
    v_pk_fma_f32 v[112:113], v[66:67], v[86:87], v[112:113]
    v_pk_fma_f32 v[114:115], v[68:69], v[88:89], v[114:115]
    v_pk_fma_f32 v[112:113], v[70:71], v[90:91], v[112:113]
    v_pk_fma_f32 v[114:115], v[72:73], v[92:93], v[114:115]
    v_pk_fma_f32 v[112:113], v[74:75], v[94:95], v[112:113]
    v_pk_fma_f32 v[114:115], v[76:77], v[96:97], v[114:115]
    v_add_f32 v112, v112, v113
    v_add_f32 v114, v114, v115
    s_add_u32 s60, s60, 0x10000
    s_add_u32 s61, s61, 0x10000
    v_mfma_f32_16x16x4_f32 v[104:107], v5, v112, v[104:107]
    v_mfma_f32_16x16x4_f32 v[108:111], v5, v114, v[108:111]
    s_add_u32 s62, s62, 1
    s_cmp_lt_u32 s62, 12
    s_cbranch_scc1 L_tloopa
    s_branch L_tend
L_ctrl2:
    s_getreg_b32 s68, hwreg(HW_REG_XCC_ID, 0, 4)
    s_lshl_b32 s68, s68, 28
    s_lshl_b32 s52, s30, 7
    s_add_u32 s52, s52, 8192
    s_lshl2_add_u32 s53, s33, s52
    s_waitcnt lgkmcnt(0)
    s_mul_i32 s70, s70, 1664525
    s_add_u32 s70, s70, 1013904223
    s_and_b32 s69, s70, 0x0fffffff
    s_or_b32 s68, s68, s69
    v_mov_b32 v13, s70
    v_mov_b32 v3, s68
    s_mov_b64 exec, 1
    buffer_store_dword v3, off, s[44:47], s53
    ds_write2_b32 v255, v254, v13 offset0:7 offset1:8
    s_mov_b64 exec, -1
    v_lshlrev_b32 v2, 3, v0
    global_load_dwordx2 v[144:145], v2, s[16:17] offset:3072
    global_load_dwordx2 v[148:149], v2, s[18:19] offset:3072
    global_load_dwordx2 v[152:153], v2, s[20:21] offset:3072
    v_and_b32 v4, 15, v0
    v_lshrrev_b32 v5, 4, v0
    v_mul_u32_u24 v6, 896, v4
    v_lshl_add_u32 v6, v5, 4, v6
    s_mul_i32 s56, s55, 448
    s_sub_u32 s57, 152000, s56
    s_add_u32 s56, s56, 151552
    v_add_u32 v7, s57, v6
    v_add_u32 v6, s56, v6
    v_mov_b32 v1, 0x3f803f80
    v_mov_b32 v16, v1
    v_mov_b32 v17, v1
    v_mov_b32 v18, v1
    v_mov_b32 v19, v1
    v_mov_b32 v20, v1
    v_mov_b32 v21, v1
    v_mov_b32 v22, v1
    v_mov_b32 v23, v1
    v_mov_b32 v24, v1
    v_mov_b32 v25, v1
    v_mov_b32 v26, v1
    v_mov_b32 v27, v1
    v_mov_b32 v28, v1
    v_mov_b32 v29, v1
    v_mov_b32 v30, v1
    v_mov_b32 v31, v1
    v_mov_b32 v32, v1
    v_mov_b32 v33, v1
    v_mov_b32 v34, v1
    v_mov_b32 v35, v1
    v_mov_b32 v36, v1
    v_mov_b32 v37, v1
    v_mov_b32 v38, v1
    v_mov_b32 v39, v1
    v_mov_b32 v40, v1
    v_mov_b32 v41, v1
    v_mov_b32 v42, v1
    v_mov_b32 v43, v1
    v_mov_b32 v44, v1
    v_mov_b32 v45, v1
    v_mov_b32 v46, v1
    v_mov_b32 v47, v1
    v_mov_b32 v48, v1
    v_mov_b32 v49, v1
    v_mov_b32 v50, v1
    v_mov_b32 v51, v1
    v_mov_b32 v52, v1
    v_mov_b32 v53, v1
    v_mov_b32 v54, v1
    v_mov_b32 v55, v1
    v_mov_b32 v56, v1
    v_mov_b32 v57, v1
    v_mov_b32 v58, v1
    v_mov_b32 v59, v1
    v_mov_b32 v60, v1
    v_mov_b32 v61, v1
    v_mov_b32 v62, v1
    v_mov_b32 v63, v1
    v_mov_b32 v64, v1
    v_mov_b32 v65, v1
    v_mov_b32 v66, v1
    v_mov_b32 v67, v1
    v_mov_b32 v68, v1
    v_mov_b32 v69, v1
    v_mov_b32 v70, v1
    v_mov_b32 v71, v1
    s_waitcnt vmcnt(32) lgkmcnt(0)
    s_mov_b32 exec_lo, 0x00ff00ff
    s_mov_b32 exec_hi, 0x00ff00ff
    ds_read_b128 v[16:19], v6 offset:0
    ds_read_b128 v[20:23], v6 offset:64
    ds_read_b128 v[24:27], v6 offset:128
    ds_read_b128 v[28:31], v6 offset:192
    ds_read_b128 v[32:35], v6 offset:256
    ds_read_b128 v[36:39], v6 offset:320
    ds_read_b128 v[40:43], v6 offset:384
    ds_read_b128 v[44:47], v7 offset:0
    ds_read_b128 v[48:51], v7 offset:64
    ds_read_b128 v[52:55], v7 offset:128
    ds_read_b128 v[56:59], v7 offset:192
    ds_read_b128 v[60:63], v7 offset:256
    ds_read_b128 v[64:67], v7 offset:320
    ds_read_b128 v[68:71], v7 offset:384
    s_mov_b64 exec, -1
    v_lshrrev_b32 v14, 2, v4
    v_lshl_add_u32 v14, v5, 3, v14
    v_lshlrev_b32 v14, 7, v14
    v_and_b32 v8, 3, v0
    v_lshl_add_u32 v14, v8, 3, v14
    v_and_b32 v9, 24, v0
    v_lshl_add_u32 v14, v9, 2, v14
    v_add_u32 v240, 122880, v14
    v_xor_b32 v241, 32, v240
    v_xor_b32 v242, 64, v240
    v_xor_b32 v243, 96, v240
    s_waitcnt lgkmcnt(13)
    v_mfma_f32_16x16x32_bf16 v[136:139], v[16:19], v[16:19], 0
    s_waitcnt lgkmcnt(12)
    v_mfma_f32_16x16x32_bf16 v[136:139], v[20:23], v[20:23], v[136:139]
    s_waitcnt lgkmcnt(11)
    v_mfma_f32_16x16x32_bf16 v[136:139], v[24:27], v[24:27], v[136:139]
    s_waitcnt lgkmcnt(10)
    v_mfma_f32_16x16x32_bf16 v[136:139], v[28:31], v[28:31], v[136:139]
    s_waitcnt lgkmcnt(9)
    v_mfma_f32_16x16x32_bf16 v[136:139], v[32:35], v[32:35], v[136:139]
    s_waitcnt lgkmcnt(8)
    v_mfma_f32_16x16x32_bf16 v[136:139], v[36:39], v[36:39], v[136:139]
    s_waitcnt lgkmcnt(7)
    v_mfma_f32_16x16x32_bf16 v[136:139], v[40:43], v[40:43], v[136:139]
    s_waitcnt lgkmcnt(6)
    v_mfma_f32_16x16x32_bf16 v[136:139], v[44:47], v[44:47], v[136:139]
    s_waitcnt lgkmcnt(5)
    v_mfma_f32_16x16x32_bf16 v[136:139], v[48:51], v[48:51], v[136:139]
    s_waitcnt lgkmcnt(4)
    v_mfma_f32_16x16x32_bf16 v[136:139], v[52:55], v[52:55], v[136:139]
    s_waitcnt lgkmcnt(3)
    v_mfma_f32_16x16x32_bf16 v[136:139], v[56:59], v[56:59], v[136:139]
    s_waitcnt lgkmcnt(2)
    v_mfma_f32_16x16x32_bf16 v[136:139], v[60:63], v[60:63], v[136:139]
    s_waitcnt lgkmcnt(1)
    v_mfma_f32_16x16x32_bf16 v[136:139], v[64:67], v[64:67], v[136:139]
    s_waitcnt lgkmcnt(0)
    v_mfma_f32_16x16x32_bf16 v[136:139], v[68:71], v[68:71], v[136:139]
    v_add_u32 v9, 32, v4
    v_lshlrev_b32 v9, 2, v9
    v_and_b32 v10, 4, v0
    v_lshl_add_u32 v10, v10, 2, v4
    v_lshlrev_b32 v10, 2, v10
    v_cmp_eq_u32 vcc, 1, v8
    v_cmp_eq_u32 s[60:61], 2, v8
    v_cmp_eq_u32 s[62:63], 3, v8
    v_cndmask_b32 v11, v136, v137, vcc
    v_cndmask_b32 v11, v11, v138, s[60:61]
    v_cndmask_b32 v11, v11, v139, s[62:63]
    ds_bpermute_b32 v9, v9, v136
    ds_bpermute_b32 v10, v10, v11
    v_mul_u32_u24 v6, 272, v4
    v_lshl_add_u32 v6, v5, 4, v6
    v_add_u32 v6, 151552, v6
    v_lshlrev_b32 v4, 4, v4
    v_mul_u32_u24 v7, 272, v5
    v_add_u32 v7, v7, v4
    v_add_u32 v7, 151552, v7
    v_lshl_add_u32 v14, v5, 15, v4
    s_lshl_b32 s50, s30, 12
    s_lshl1_add_u32 s51, s31, s32
    s_lshl_b32 s51, s51, 8
    s_add_u32 s50, s50, s51
    s_add_u32 s50, s50, 1048576
    s_add_u32 s51, s50, 0x20000
    s_waitcnt lgkmcnt(0)
    v_mov_b32 v11, 0x3b124925
    v_mul_f32 v9, v9, v11
    v_mul_f32 v10, v10, v11
    v_fma_f32 v10, -v9, v9, v10
    v_max_f32 v10, 0, v10
    v_add_f32 v10, 0x3727c5ac, v10
    v_rsq_f32 v10, v10
    v_sub_f32 v9, 0, v9
    s_waitcnt vmcnt(28)
    ds_read_b64_tr_b16 v[72:73], v240 offset:0
    ds_read_b64_tr_b16 v[74:75], v240 offset:512
    ds_read_b64_tr_b16 v[76:77], v241 offset:0
    ds_read_b64_tr_b16 v[78:79], v241 offset:512
    ds_read_b64_tr_b16 v[80:81], v242 offset:0
    ds_read_b64_tr_b16 v[82:83], v242 offset:512
    ds_read_b64_tr_b16 v[84:85], v243 offset:0
    ds_read_b64_tr_b16 v[86:87], v243 offset:512
    s_waitcnt vmcnt(24)
    ds_read_b64_tr_b16 v[88:89], v240 offset:4096
    ds_read_b64_tr_b16 v[90:91], v240 offset:4608
    ds_read_b64_tr_b16 v[92:93], v241 offset:4096
    ds_read_b64_tr_b16 v[94:95], v241 offset:4608
    ds_read_b64_tr_b16 v[96:97], v242 offset:4096
    ds_read_b64_tr_b16 v[98:99], v242 offset:4608
    ds_read_b64_tr_b16 v[100:101], v243 offset:4096
    ds_read_b64_tr_b16 v[102:103], v243 offset:4608
    s_waitcnt lgkmcnt(14)
    v_mfma_f32_16x16x32_bf16 v[104:107], v[72:75], v[16:19], 0
    s_waitcnt lgkmcnt(12)
    v_mfma_f32_16x16x32_bf16 v[108:111], v[76:79], v[16:19], 0
    s_waitcnt lgkmcnt(10)
    v_mfma_f32_16x16x32_bf16 v[112:115], v[80:83], v[16:19], 0
    s_waitcnt lgkmcnt(8)
    v_mfma_f32_16x16x32_bf16 v[116:119], v[84:87], v[16:19], 0
    s_waitcnt vmcnt(20)
    ds_read_b64_tr_b16 v[72:73], v240 offset:8192
    ds_read_b64_tr_b16 v[74:75], v240 offset:8704
    ds_read_b64_tr_b16 v[76:77], v241 offset:8192
    ds_read_b64_tr_b16 v[78:79], v241 offset:8704
    ds_read_b64_tr_b16 v[80:81], v242 offset:8192
    ds_read_b64_tr_b16 v[82:83], v242 offset:8704
    ds_read_b64_tr_b16 v[84:85], v243 offset:8192
    ds_read_b64_tr_b16 v[86:87], v243 offset:8704
    s_waitcnt lgkmcnt(14)
    v_mfma_f32_16x16x32_bf16 v[104:107], v[88:91], v[20:23], v[104:107]
    s_waitcnt lgkmcnt(12)
    v_mfma_f32_16x16x32_bf16 v[108:111], v[92:95], v[20:23], v[108:111]
    s_waitcnt lgkmcnt(10)
    v_mfma_f32_16x16x32_bf16 v[112:115], v[96:99], v[20:23], v[112:115]
    s_waitcnt lgkmcnt(8)
    v_mfma_f32_16x16x32_bf16 v[116:119], v[100:103], v[20:23], v[116:119]
    s_waitcnt vmcnt(16)
    ds_read_b64_tr_b16 v[88:89], v240 offset:12288
    ds_read_b64_tr_b16 v[90:91], v240 offset:12800
    ds_read_b64_tr_b16 v[92:93], v241 offset:12288
    ds_read_b64_tr_b16 v[94:95], v241 offset:12800
    ds_read_b64_tr_b16 v[96:97], v242 offset:12288
    ds_read_b64_tr_b16 v[98:99], v242 offset:12800
    ds_read_b64_tr_b16 v[100:101], v243 offset:12288
    ds_read_b64_tr_b16 v[102:103], v243 offset:12800
    s_waitcnt lgkmcnt(14)
    v_mfma_f32_16x16x32_bf16 v[104:107], v[72:75], v[24:27], v[104:107]
    s_waitcnt lgkmcnt(12)
    v_mfma_f32_16x16x32_bf16 v[108:111], v[76:79], v[24:27], v[108:111]
    s_waitcnt lgkmcnt(10)
    v_mfma_f32_16x16x32_bf16 v[112:115], v[80:83], v[24:27], v[112:115]
    s_waitcnt lgkmcnt(8)
    v_mfma_f32_16x16x32_bf16 v[116:119], v[84:87], v[24:27], v[116:119]
    s_waitcnt vmcnt(12)
    ds_read_b64_tr_b16 v[72:73], v240 offset:16384
    ds_read_b64_tr_b16 v[74:75], v240 offset:16896
    ds_read_b64_tr_b16 v[76:77], v241 offset:16384
    ds_read_b64_tr_b16 v[78:79], v241 offset:16896
    ds_read_b64_tr_b16 v[80:81], v242 offset:16384
    ds_read_b64_tr_b16 v[82:83], v242 offset:16896
    ds_read_b64_tr_b16 v[84:85], v243 offset:16384
    ds_read_b64_tr_b16 v[86:87], v243 offset:16896
    s_waitcnt lgkmcnt(14)
    v_mfma_f32_16x16x32_bf16 v[104:107], v[88:91], v[28:31], v[104:107]
    s_waitcnt lgkmcnt(12)
    v_mfma_f32_16x16x32_bf16 v[108:111], v[92:95], v[28:31], v[108:111]
    s_waitcnt lgkmcnt(10)
    v_mfma_f32_16x16x32_bf16 v[112:115], v[96:99], v[28:31], v[112:115]
    s_waitcnt lgkmcnt(8)
    v_mfma_f32_16x16x32_bf16 v[116:119], v[100:103], v[28:31], v[116:119]
    s_waitcnt vmcnt(8)
    ds_read_b64_tr_b16 v[88:89], v240 offset:20480
    ds_read_b64_tr_b16 v[90:91], v240 offset:20992
    ds_read_b64_tr_b16 v[92:93], v241 offset:20480
    ds_read_b64_tr_b16 v[94:95], v241 offset:20992
    ds_read_b64_tr_b16 v[96:97], v242 offset:20480
    ds_read_b64_tr_b16 v[98:99], v242 offset:20992
    ds_read_b64_tr_b16 v[100:101], v243 offset:20480
    ds_read_b64_tr_b16 v[102:103], v243 offset:20992
    s_waitcnt lgkmcnt(14)
    v_mfma_f32_16x16x32_bf16 v[104:107], v[72:75], v[32:35], v[104:107]
    s_waitcnt lgkmcnt(12)
    v_mfma_f32_16x16x32_bf16 v[108:111], v[76:79], v[32:35], v[108:111]
    s_waitcnt lgkmcnt(10)
    v_mfma_f32_16x16x32_bf16 v[112:115], v[80:83], v[32:35], v[112:115]
    s_waitcnt lgkmcnt(8)
    v_mfma_f32_16x16x32_bf16 v[116:119], v[84:87], v[32:35], v[116:119]
    s_waitcnt vmcnt(4)
    ds_read_b64_tr_b16 v[72:73], v240 offset:24576
    ds_read_b64_tr_b16 v[74:75], v240 offset:25088
    ds_read_b64_tr_b16 v[76:77], v241 offset:24576
    ds_read_b64_tr_b16 v[78:79], v241 offset:25088
    ds_read_b64_tr_b16 v[80:81], v242 offset:24576
    ds_read_b64_tr_b16 v[82:83], v242 offset:25088
    ds_read_b64_tr_b16 v[84:85], v243 offset:24576
    ds_read_b64_tr_b16 v[86:87], v243 offset:25088
    s_waitcnt lgkmcnt(14)
    v_mfma_f32_16x16x32_bf16 v[104:107], v[88:91], v[36:39], v[104:107]
    s_waitcnt lgkmcnt(12)
    v_mfma_f32_16x16x32_bf16 v[108:111], v[92:95], v[36:39], v[108:111]
    s_waitcnt lgkmcnt(10)
    v_mfma_f32_16x16x32_bf16 v[112:115], v[96:99], v[36:39], v[112:115]
    s_waitcnt lgkmcnt(8)
    v_mfma_f32_16x16x32_bf16 v[116:119], v[100:103], v[36:39], v[116:119]
    s_waitcnt lgkmcnt(6)
    v_mfma_f32_16x16x32_bf16 v[104:107], v[72:75], v[40:43], v[104:107]
    s_waitcnt lgkmcnt(4)
    v_mfma_f32_16x16x32_bf16 v[108:111], v[76:79], v[40:43], v[108:111]
    s_waitcnt lgkmcnt(2)
    v_mfma_f32_16x16x32_bf16 v[112:115], v[80:83], v[40:43], v[112:115]
    s_waitcnt lgkmcnt(0)
    v_mfma_f32_16x16x32_bf16 v[116:119], v[84:87], v[40:43], v[116:119]
    s_nop 1
    v_fmac_f32_dpp v104, v104, v9 row_newbcast:8 row_mask:0xf bank_mask:0xf
    v_fmac_f32_dpp v105, v105, v9 row_newbcast:8 row_mask:0xf bank_mask:0xf
    v_fmac_f32_dpp v106, v106, v9 row_newbcast:8 row_mask:0xf bank_mask:0xf
    v_fmac_f32_dpp v107, v107, v9 row_newbcast:8 row_mask:0xf bank_mask:0xf
    v_fmac_f32_dpp v108, v108, v9 row_newbcast:8 row_mask:0xf bank_mask:0xf
    v_fmac_f32_dpp v109, v109, v9 row_newbcast:8 row_mask:0xf bank_mask:0xf
    v_fmac_f32_dpp v110, v110, v9 row_newbcast:8 row_mask:0xf bank_mask:0xf
    v_fmac_f32_dpp v111, v111, v9 row_newbcast:8 row_mask:0xf bank_mask:0xf
    v_fmac_f32_dpp v112, v112, v9 row_newbcast:8 row_mask:0xf bank_mask:0xf
    v_fmac_f32_dpp v113, v113, v9 row_newbcast:8 row_mask:0xf bank_mask:0xf
    v_fmac_f32_dpp v114, v114, v9 row_newbcast:8 row_mask:0xf bank_mask:0xf
    v_fmac_f32_dpp v115, v115, v9 row_newbcast:8 row_mask:0xf bank_mask:0xf
    v_fmac_f32_dpp v116, v116, v9 row_newbcast:8 row_mask:0xf bank_mask:0xf
    v_fmac_f32_dpp v117, v117, v9 row_newbcast:8 row_mask:0xf bank_mask:0xf
    v_fmac_f32_dpp v118, v118, v9 row_newbcast:8 row_mask:0xf bank_mask:0xf
    v_fmac_f32_dpp v119, v119, v9 row_newbcast:8 row_mask:0xf bank_mask:0xf
    s_mov_b32 exec_lo, 0x00ff00ff
    s_mov_b32 exec_hi, 0x00ff00ff
    v_pk_mul_f32 v[104:105], v[104:105], v[10:11] op_sel_hi:[1,0]
    v_pk_mul_f32 v[106:107], v[106:107], v[10:11] op_sel_hi:[1,0]
    ds_write_b128 v6, v[104:107] offset:0
    v_pk_mul_f32 v[108:109], v[108:109], v[10:11] op_sel_hi:[1,0]
    v_pk_mul_f32 v[110:111], v[110:111], v[10:11] op_sel_hi:[1,0]
    ds_write_b128 v6, v[108:111] offset:64
    v_pk_mul_f32 v[112:113], v[112:113], v[10:11] op_sel_hi:[1,0]
    v_pk_mul_f32 v[114:115], v[114:115], v[10:11] op_sel_hi:[1,0]
    ds_write_b128 v6, v[112:115] offset:128
    v_pk_mul_f32 v[116:117], v[116:117], v[10:11] op_sel_hi:[1,0]
    v_pk_mul_f32 v[118:119], v[118:119], v[10:11] op_sel_hi:[1,0]
    ds_write_b128 v6, v[116:119] offset:192
    s_mov_b64 exec, -1
    ds_read_b128 v[120:123], v7 offset:0
    ds_read_b128 v[124:127], v7 offset:1088
    s_waitcnt lgkmcnt(0)
    v_bfi_b32 v120, s71, v13, v120
    v_bfi_b32 v121, s71, v13, v121
    v_bfi_b32 v122, s71, v13, v122
    v_bfi_b32 v123, s71, v13, v123
    v_bfi_b32 v124, s71, v13, v124
    v_bfi_b32 v125, s71, v13, v125
    v_bfi_b32 v126, s71, v13, v126
    v_bfi_b32 v127, s71, v13, v127
    v_and_b32 v128, 31, v0
    v_lshlrev_b32 v128, 2, v128
    s_mov_b32 s59, 1
L_hp:
    buffer_load_dword v15, v128, s[44:47], s52 offen sc1
    s_waitcnt vmcnt(0)
    v_cmp_ne_u32 vcc, s68, v15
    s_cbranch_vccz L_hd
    s_sub_u32 s59, s59, 1
    s_cbranch_scc0 L_hp
L_hd:
    s_cbranch_vccnz L_qslow
    buffer_store_dwordx4 v[120:123], v14, s[44:47], s50 offen
    buffer_store_dwordx4 v[124:127], v14, s[44:47], s51 offen
    s_branch L_qpd
L_qslow:
    buffer_store_dwordx4 v[120:123], v14, s[44:47], s50 offen sc1
    buffer_store_dwordx4 v[124:127], v14, s[44:47], s51 offen sc1
    s_branch L_qpd
L_noqp:
    v_lshlrev_b32 v2, 3, v0
    global_load_dwordx2 v[144:145], v2, s[16:17] offset:3072
    global_load_dwordx2 v[148:149], v2, s[18:19] offset:3072
    global_load_dwordx2 v[152:153], v2, s[20:21] offset:3072
    s_getreg_b32 s68, hwreg(HW_REG_XCC_ID, 0, 4)
    s_lshl_b32 s68, s68, 28
    s_lshl_b32 s52, s30, 7
    s_add_u32 s52, s52, 8192
    s_lshl2_add_u32 s53, s33, s52
    s_waitcnt lgkmcnt(0)
    s_mul_i32 s70, s70, 1664525
    s_add_u32 s70, s70, 1013904223
    s_and_b32 s69, s70, 0x0fffffff
    s_or_b32 s68, s68, s69
    v_mov_b32 v13, s70
    v_mov_b32 v3, s68
    s_mov_b64 exec, 1
    buffer_store_dword v3, off, s[44:47], s53
    ds_write2_b32 v255, v254, v13 offset0:7 offset1:8
    s_mov_b64 exec, -1
    s_waitcnt vmcnt(1)
L_qpd:
    s_setprio 0
    s_and_b32 s60, s2, 127
    s_mul_i32 s60, s60, 24
    s_add_u32 s60, s60, 13824
    s_lshr_b32 s61, s2, 7
    s_lshl_b32 s61, s61, 15
    s_add_u32 s60, s60, s61
    s_lshl_b32 s60, s60, 16
    s_add_u32 s61, s60, 786432
    v_mov_b32 v38, 0xbdd2d3e8
    v_mov_b32 v39, 0xc0135761
    v_and_b32 v4, 15, v0
    v_mov_b32 v104, 0
    v_mov_b32 v105, 0
    v_mov_b32 v106, 0
    v_mov_b32 v107, 0
    v_mov_b32 v108, 0
    v_mov_b32 v109, 0
    v_mov_b32 v110, 0
    v_mov_b32 v111, 0
    s_mov_b32 s62, 0
    v_lshlrev_b32 v8, 16, v144
    v_and_b32 v9, 0xffff0000, v144
    v_lshlrev_b32 v10, 16, v145
    v_and_b32 v11, 0xffff0000, v145
    v_lshlrev_b32 v18, 16, v148
    v_and_b32 v19, 0xffff0000, v148
    v_lshlrev_b32 v20, 16, v149
    v_and_b32 v21, 0xffff0000, v149
    v_lshlrev_b32 v28, 16, v152
    v_and_b32 v29, 0xffff0000, v152
    v_lshlrev_b32 v30, 16, v153
    v_and_b32 v31, 0xffff0000, v153
.p2align 3
L_tloopb:
    v_cmp_eq_u32_e64 vcc, s62, v4
    v_pk_fma_f32 v[62:63], v[8:9], s[60:61], v[18:19] op_sel:[0,0,0] op_sel_hi:[1,0,1]
    v_pk_fma_f32 v[64:65], v[8:9], s[60:61], v[18:19] op_sel:[0,1,0] op_sel_hi:[1,1,1]
    v_pk_fma_f32 v[66:67], v[10:11], s[60:61], v[20:21] op_sel:[0,0,0] op_sel_hi:[1,0,1]
    v_pk_fma_f32 v[68:69], v[10:11], s[60:61], v[20:21] op_sel:[0,1,0] op_sel_hi:[1,1,1]
    v_cndmask_b32 v5, 0, 1.0, vcc
    v_pk_mul_f32 v[82:83], v[62:63], v[62:63]
    v_pk_mul_f32 v[84:85], v[64:65], v[64:65]
    v_pk_mul_f32 v[86:87], v[66:67], v[66:67]
    v_pk_mul_f32 v[88:89], v[68:69], v[68:69]
    v_pk_fma_f32 v[82:83], v[82:83], v[38:39], v[38:39] op_sel:[0,0,1] op_sel_hi:[1,0,1]
    v_pk_fma_f32 v[84:85], v[84:85], v[38:39], v[38:39] op_sel:[0,0,1] op_sel_hi:[1,0,1]
    v_pk_fma_f32 v[86:87], v[86:87], v[38:39], v[38:39] op_sel:[0,0,1] op_sel_hi:[1,0,1]
    v_pk_fma_f32 v[88:89], v[88:89], v[38:39], v[38:39] op_sel:[0,0,1] op_sel_hi:[1,0,1]
    v_pk_mul_f32 v[82:83], v[82:83], v[62:63]
    v_pk_mul_f32 v[84:85], v[84:85], v[64:65]
    v_pk_mul_f32 v[86:87], v[86:87], v[66:67]
    v_pk_mul_f32 v[88:89], v[88:89], v[68:69]
    v_exp_f32 v82, v82
    v_exp_f32 v83, v83
    v_exp_f32 v84, v84
    v_exp_f32 v85, v85
    v_exp_f32 v86, v86
    v_exp_f32 v87, v87
    v_exp_f32 v88, v88
    v_exp_f32 v89, v89
    v_pk_mul_f32 v[62:63], v[62:63], v[28:29]
    v_pk_mul_f32 v[64:65], v[64:65], v[28:29]
    v_pk_mul_f32 v[66:67], v[66:67], v[30:31]
    v_pk_mul_f32 v[68:69], v[68:69], v[30:31]
    v_pk_add_f32 v[82:83], v[82:83], 1.0 op_sel_hi:[1,0]
    v_pk_add_f32 v[84:85], v[84:85], 1.0 op_sel_hi:[1,0]
    v_pk_add_f32 v[86:87], v[86:87], 1.0 op_sel_hi:[1,0]
    v_pk_add_f32 v[88:89], v[88:89], 1.0 op_sel_hi:[1,0]
    v_rcp_f32 v82, v82
    v_rcp_f32 v83, v83
    v_rcp_f32 v84, v84
    v_rcp_f32 v85, v85
    v_rcp_f32 v86, v86
    v_rcp_f32 v87, v87
    v_rcp_f32 v88, v88
    v_rcp_f32 v89, v89
    v_pk_mul_f32 v[112:113], v[62:63], v[82:83]
    v_pk_mul_f32 v[114:115], v[64:65], v[84:85]
    v_pk_fma_f32 v[112:113], v[66:67], v[86:87], v[112:113]
    v_pk_fma_f32 v[114:115], v[68:69], v[88:89], v[114:115]
    v_add_f32 v112, v112, v113
    v_add_f32 v114, v114, v115
    s_add_u32 s60, s60, 0x10000
    s_add_u32 s61, s61, 0x10000
    v_mfma_f32_16x16x4_f32 v[104:107], v5, v112, v[104:107]
    v_mfma_f32_16x16x4_f32 v[108:111], v5, v114, v[108:111]
    s_add_u32 s62, s62, 1
    s_cmp_lt_u32 s62, 12
    s_cbranch_scc1 L_tloopb
L_tend:
    v_and_b32 v2, 48, v0
    v_add_u32 v2, 160768, v2
    s_nop 5
    v_add_f32_dpp v104, v104, v104 row_ror:8 row_mask:0xf bank_mask:0xf
    v_add_f32_dpp v105, v105, v105 row_ror:8 row_mask:0xf bank_mask:0xf
    v_add_f32_dpp v106, v106, v106 row_ror:8 row_mask:0xf bank_mask:0xf
    v_add_f32_dpp v107, v107, v107 row_ror:8 row_mask:0xf bank_mask:0xf
    v_add_f32_dpp v108, v108, v108 row_ror:8 row_mask:0xf bank_mask:0xf
    v_add_f32_dpp v109, v109, v109 row_ror:8 row_mask:0xf bank_mask:0xf
    v_add_f32_dpp v110, v110, v110 row_ror:8 row_mask:0xf bank_mask:0xf
    v_add_f32_dpp v111, v111, v111 row_ror:8 row_mask:0xf bank_mask:0xf
    v_add_f32_dpp v104, v104, v104 row_ror:4 row_mask:0xf bank_mask:0xf
    v_add_f32_dpp v105, v105, v105 row_ror:4 row_mask:0xf bank_mask:0xf
    v_add_f32_dpp v106, v106, v106 row_ror:4 row_mask:0xf bank_mask:0xf
    v_add_f32_dpp v107, v107, v107 row_ror:4 row_mask:0xf bank_mask:0xf
    v_add_f32_dpp v108, v108, v108 row_ror:4 row_mask:0xf bank_mask:0xf
    v_add_f32_dpp v109, v109, v109 row_ror:4 row_mask:0xf bank_mask:0xf
    v_add_f32_dpp v110, v110, v110 row_ror:4 row_mask:0xf bank_mask:0xf
    v_add_f32_dpp v111, v111, v111 row_ror:4 row_mask:0xf bank_mask:0xf
    v_add_f32_dpp v104, v104, v104 row_ror:2 row_mask:0xf bank_mask:0xf
    v_add_f32_dpp v105, v105, v105 row_ror:2 row_mask:0xf bank_mask:0xf
    v_add_f32_dpp v106, v106, v106 row_ror:2 row_mask:0xf bank_mask:0xf
    v_add_f32_dpp v107, v107, v107 row_ror:2 row_mask:0xf bank_mask:0xf
    v_add_f32_dpp v108, v108, v108 row_ror:2 row_mask:0xf bank_mask:0xf
    v_add_f32_dpp v109, v109, v109 row_ror:2 row_mask:0xf bank_mask:0xf
    v_add_f32_dpp v110, v110, v110 row_ror:2 row_mask:0xf bank_mask:0xf
    v_add_f32_dpp v111, v111, v111 row_ror:2 row_mask:0xf bank_mask:0xf
    v_add_f32_dpp v104, v104, v104 row_ror:1 row_mask:0xf bank_mask:0xf
    v_add_f32_dpp v105, v105, v105 row_ror:1 row_mask:0xf bank_mask:0xf
    v_add_f32_dpp v106, v106, v106 row_ror:1 row_mask:0xf bank_mask:0xf
    v_add_f32_dpp v107, v107, v107 row_ror:1 row_mask:0xf bank_mask:0xf
    v_add_f32_dpp v108, v108, v108 row_ror:1 row_mask:0xf bank_mask:0xf
    v_add_f32_dpp v109, v109, v109 row_ror:1 row_mask:0xf bank_mask:0xf
    v_add_f32_dpp v110, v110, v110 row_ror:1 row_mask:0xf bank_mask:0xf
    v_add_f32_dpp v111, v111, v111 row_ror:1 row_mask:0xf bank_mask:0xf
    s_mov_b32 exec_lo, 0x00010001
    s_mov_b32 exec_hi, 0x00000001
    ds_add_f32 v2, v104 offset:0
    ds_add_f32 v2, v105 offset:4
    ds_add_f32 v2, v106 offset:8
    ds_add_f32 v2, v107 offset:12
    ds_add_f32 v2, v108 offset:48
    ds_add_f32 v2, v109 offset:52
    ds_add_f32 v2, v110 offset:56
    ds_add_f32 v2, v111 offset:60
    s_mov_b64 exec, 1
    ds_add_rtn_u32 v1, v255, v254 offset:12
    s_waitcnt lgkmcnt(0)
    v_readfirstlane_b32 s62, v1
    s_mov_b64 exec, -1
    s_cmp_lg_u32 s62, 3
    s_cbranch_scc1 L_vload
    v_lshlrev_b32 v2, 4, v0
    v_mul_u32_u24 v3, 24, v0
    v_add_u32 v3, 160768, v3
    s_mov_b64 exec, 15
    ds_read_b64 v[12:13], v3
    ds_read_b64 v[14:15], v3 offset:8
    ds_read_b64 v[16:17], v3 offset:16
    ds_read_b32 v11, v255 offset:32
    s_lshl_b32 s62, s2, 6
    s_add_u32 s62, s62, 32768
    s_lshl_b32 s66, s67, 16
    s_waitcnt lgkmcnt(0)
    v_pk_add_f32 v[12:13], v[12:13], s[66:67] op_sel_hi:[1,0]
    v_cvt_pk_bf16_f32 v8, v12, v13
    v_pk_add_f32 v[14:15], v[14:15], s[66:67] op_sel_hi:[1,0]
    v_cvt_pk_bf16_f32 v9, v14, v15
    v_pk_add_f32 v[16:17], v[16:17], s[66:67] op_sel_hi:[1,0]
    v_cvt_pk_bf16_f32 v10, v16, v17
    s_setprio 3
    buffer_store_dwordx4 v[8:11], v2, s[44:47], s62 offen sc1
    s_setprio 0
    s_mov_b64 exec, -1
L_vload:
    s_mov_b32 s76, 0x05040100
    s_mov_b32 s77, 0x07060302
    v_lshrrev_b32 v1, 3, v0
    v_and_b32 v3, 7, v0
    v_lshlrev_b32 v2, 4, v3
    v_lshl_add_u32 v2, v1, 9, v2
    s_lshl_b32 s50, s3, 12
    s_lshl_b32 s51, s32, 7
    s_add_u32 s50, s50, s51
    s_add_u32 s50, s50, s34
    s_add_u32 s67, s3, 4
    s_movk_i32 s73, 16384
    v_and_b32 v4, 1, v0
    v_lshlrev_b32 v5, 7, v4
    v_and_b32 v6, 4, v0
    v_lshl_add_u32 v5, v6, 4, v5
    v_and_b32 v6, 48, v0
    s_lshl_b32 s51, s3, 10
    s_add_u32 s51, s51, 155648
    v_add3_u32 v252, v5, v6, s51
    v_bfe_u32 v4, v0, 3, 1
    v_mul_u32_u24 v4, 144, v4
    v_and_b32 v5, 16, v0
    v_lshl_add_u32 v4, v5, 2, v4
    v_lshl_add_u32 v4, v3, 3, v4
    s_mul_i32 s51, s3, 288
    s_add_u32 s51, s51, 161024
    s_and_b32 s52, s31, 4
    s_add_u32 s51, s51, s52
    v_add_u32 v253, s51, v4
    v_xor_b32 v251, 4, v253
    s_mov_b32 s36, s8
    s_mov_b32 s37, s9
    s_mov_b32 s38, 134217728
    s_mov_b32 s39, 0x20000
    s_mul_i32 s65, s31, 896
    s_mul_i32 s66, s67, 112
    s_add_u32 s65, s65, s66
    v_max_u32 v247, 8, v0
    v_subrev_u32 v247, 8, v247
    v_lshl_add_u32 v247, v247, 1, s65
    v_lshrrev_b32 v240, 3, v0
    v_lshlrev_b32 v240, 10, v240
    v_and_b32 v241, 7, v0
    v_lshl_add_u32 v240, v241, 4, v240
    v_add_u32 v241, 0x2000, v240
    v_add_u32 v242, 0x4000, v240
    v_add_u32 v243, 0x6000, v240
    s_cmp_lg_u32 s75, 2
    s_cbranch_scc1 L_vprep
    global_load_ushort v248, v247, s[4:5]
    s_lshl_b32 s64, s31, 8
    s_add_u32 s64, s64, s67
    s_lshl_b32 s64, s64, 7
    s_add_u32 s64, s64, 786432
    s_lshl_b32 s66, s67, 3
    v_mov_b32 v246, 0
    v_add_u32 v245, s66, v246
    v_mov_b32 v249, 0x00003f80
    v_mov_b32 v250, 0x3f800000
L_vprep:
    s_cmp_eq_u32 s75, 2
    s_cselect_b64 vcc, -1, 0
    s_mov_b32 s78, 0x100000
L_spin15:
    ds_read_b32 v1, v255 offset:0
    s_waitcnt lgkmcnt(0)
    v_readfirstlane_b32 s79, v1
    s_cmp_ge_u32 s79, 4
    s_cbranch_scc1 L_spind16
    s_sleep 1
    s_sub_u32 s78, s78, 1
    s_cbranch_scc0 L_spin15
L_spind16:
    buffer_load_dwordx4 v[40:43], v2, s[36:39], s50 offen nt
    s_add_u32 s50, s50, s73
    buffer_load_dwordx4 v[44:47], v2, s[36:39], s50 offen nt
    s_add_u32 s50, s50, s73
    buffer_load_dwordx4 v[48:51], v2, s[36:39], s50 offen nt
    s_add_u32 s50, s50, s73
    buffer_load_dwordx4 v[52:55], v2, s[36:39], s50 offen nt
    s_add_u32 s50, s50, s73
    buffer_load_dwordx4 v[56:59], v2, s[36:39], s50 offen nt
    s_add_u32 s50, s50, s73
    s_cbranch_vccnz L_vt5
    s_waitcnt vmcnt(4)
L_vt5:
    buffer_load_dwordx4 v[60:63], v2, s[36:39], s50 offen nt
    s_add_u32 s50, s50, s73
    s_cbranch_vccnz L_vt6
    s_waitcnt vmcnt(4)
L_vt6:
    buffer_load_dwordx4 v[64:67], v2, s[36:39], s50 offen nt
    s_add_u32 s50, s50, s73
    s_cbranch_vccnz L_vt7
    s_waitcnt vmcnt(4)
L_vt7:
    buffer_load_dwordx4 v[68:71], v2, s[36:39], s50 offen nt
    s_add_u32 s50, s50, s73
    s_cbranch_vccnz L_vt8
    s_waitcnt vmcnt(6)
L_vt8:
    buffer_load_dwordx4 v[72:75], v2, s[36:39], s50 offen nt
    s_add_u32 s50, s50, s73
    s_cbranch_vccnz L_vt9
    s_waitcnt vmcnt(6)
L_vt9:
    buffer_load_dwordx4 v[76:79], v2, s[36:39], s50 offen nt
    s_add_u32 s50, s50, s73
    s_cbranch_vccnz L_vt10
    s_waitcnt vmcnt(6)
L_vt10:
    buffer_load_dwordx4 v[80:83], v2, s[36:39], s50 offen nt
    s_add_u32 s50, s50, s73
    s_cbranch_vccnz L_vt11
    s_waitcnt vmcnt(6)
L_vt11:
    buffer_load_dwordx4 v[84:87], v2, s[36:39], s50 offen nt
    s_add_u32 s50, s50, s73
    s_waitcnt vmcnt(10)
    v_perm_b32 v8, v44, v40, s76
    v_perm_b32 v12, v44, v40, s77
    v_perm_b32 v16, v45, v41, s76
    v_perm_b32 v20, v45, v41, s77
    v_perm_b32 v24, v46, v42, s76
    v_perm_b32 v28, v46, v42, s77
    v_perm_b32 v32, v47, v43, s76
    v_perm_b32 v36, v47, v43, s77
    s_cbranch_vccnz L_vt12
    s_waitcnt vmcnt(6)
L_vt12:
    buffer_load_dwordx4 v[88:91], v2, s[36:39], s50 offen nt
    s_add_u32 s50, s50, s73
    s_cbranch_vccnz L_vt13
    s_waitcnt vmcnt(6)
L_vt13:
    buffer_load_dwordx4 v[92:95], v2, s[36:39], s50 offen nt
    s_add_u32 s50, s50, s73
    s_waitcnt vmcnt(10)
    v_perm_b32 v9, v52, v48, s76
    v_perm_b32 v13, v52, v48, s77
    v_perm_b32 v17, v53, v49, s76
    v_perm_b32 v21, v53, v49, s77
    v_perm_b32 v25, v54, v50, s76
    v_perm_b32 v29, v54, v50, s77
    v_perm_b32 v33, v55, v51, s76
    v_perm_b32 v37, v55, v51, s77
    s_cbranch_vccnz L_vt14
    s_waitcnt vmcnt(6)
L_vt14:
    buffer_load_dwordx4 v[96:99], v2, s[36:39], s50 offen nt
    s_add_u32 s50, s50, s73
    s_mov_b64 exec, 1
    ds_add_u32 v255, v254 offset:48
    s_mov_b64 exec, -1
    s_cbranch_vccnz L_vt15
    s_waitcnt vmcnt(6)
L_vt15:
    buffer_load_dwordx4 v[100:103], v2, s[36:39], s50 offen nt
    s_add_u32 s50, s50, s73
    s_waitcnt vmcnt(10)
    v_perm_b32 v10, v60, v56, s76
    v_perm_b32 v14, v60, v56, s77
    v_perm_b32 v18, v61, v57, s76
    v_perm_b32 v22, v61, v57, s77
    v_perm_b32 v26, v62, v58, s76
    v_perm_b32 v30, v62, v58, s77
    v_perm_b32 v34, v63, v59, s76
    v_perm_b32 v38, v63, v59, s77
    s_cbranch_vccnz L_vt16
    s_waitcnt vmcnt(6)
L_vt16:
    buffer_load_dwordx4 v[104:107], v2, s[36:39], s50 offen nt
    s_add_u32 s50, s50, s73
    s_cbranch_vccnz L_vt17
    s_waitcnt vmcnt(6)
L_vt17:
    buffer_load_dwordx4 v[108:111], v2, s[36:39], s50 offen nt
    s_add_u32 s50, s50, s73
    s_mov_b64 exec, 1
    ds_add_u32 v255, v254 offset:48
    s_mov_b64 exec, -1
    s_waitcnt vmcnt(10)
    v_perm_b32 v11, v68, v64, s76
    v_perm_b32 v15, v68, v64, s77
    v_perm_b32 v19, v69, v65, s76
    v_perm_b32 v23, v69, v65, s77
    v_perm_b32 v27, v70, v66, s76
    v_perm_b32 v31, v70, v66, s77
    v_perm_b32 v35, v71, v67, s76
    v_perm_b32 v39, v71, v67, s77
    s_cbranch_vccnz L_vt18
    s_waitcnt vmcnt(6)
L_vt18:
    buffer_load_dwordx4 v[112:115], v2, s[36:39], s50 offen nt
    s_add_u32 s50, s50, s73
    s_cbranch_vccnz L_vt19
    s_waitcnt vmcnt(6)
L_vt19:
    buffer_load_dwordx4 v[116:119], v2, s[36:39], s50 offen nt
    s_add_u32 s50, s50, s73
    s_waitcnt vmcnt(10)
    v_perm_b32 v40, v76, v72, s76
    v_perm_b32 v44, v76, v72, s77
    v_perm_b32 v48, v77, v73, s76
    v_perm_b32 v52, v77, v73, s77
    v_perm_b32 v56, v78, v74, s76
    v_perm_b32 v60, v78, v74, s77
    v_perm_b32 v64, v79, v75, s76
    v_perm_b32 v68, v79, v75, s77
    s_cbranch_vccnz L_vt20
    s_waitcnt vmcnt(6)
L_vt20:
    buffer_load_dwordx4 v[120:123], v2, s[36:39], s50 offen nt
    s_add_u32 s50, s50, s73
    s_cbranch_vccnz L_vt21
    s_waitcnt vmcnt(6)
L_vt21:
    buffer_load_dwordx4 v[124:127], v2, s[36:39], s50 offen nt
    s_add_u32 s50, s50, s73
    s_waitcnt vmcnt(10)
    v_perm_b32 v41, v84, v80, s76
    v_perm_b32 v45, v84, v80, s77
    v_perm_b32 v49, v85, v81, s76
    v_perm_b32 v53, v85, v81, s77
    v_perm_b32 v57, v86, v82, s76
    v_perm_b32 v61, v86, v82, s77
    v_perm_b32 v65, v87, v83, s76
    v_perm_b32 v69, v87, v83, s77
    s_cbranch_vccnz L_vt22
    s_waitcnt vmcnt(6)
L_vt22:
    buffer_load_dwordx4 v[128:131], v2, s[36:39], s50 offen nt
    s_add_u32 s50, s50, s73
    s_cbranch_vccnz L_vt23
    s_waitcnt vmcnt(6)
L_vt23:
    buffer_load_dwordx4 v[132:135], v2, s[36:39], s50 offen nt
    s_add_u32 s50, s50, s73
    s_waitcnt vmcnt(10)
    v_perm_b32 v42, v92, v88, s76
    v_perm_b32 v46, v92, v88, s77
    v_perm_b32 v50, v93, v89, s76
    v_perm_b32 v54, v93, v89, s77
    v_perm_b32 v58, v94, v90, s76
    v_perm_b32 v62, v94, v90, s77
    v_perm_b32 v66, v95, v91, s76
    v_perm_b32 v70, v95, v91, s77
    s_cbranch_vccnz L_vt24
    s_waitcnt vmcnt(6)
L_vt24:
    buffer_load_dwordx4 v[136:139], v2, s[36:39], s50 offen nt
    s_add_u32 s50, s50, s73
    s_cbranch_vccnz L_vt25
    s_waitcnt vmcnt(6)
L_vt25:
    buffer_load_dwordx4 v[140:143], v2, s[36:39], s50 offen nt
    s_add_u32 s50, s50, s73
    s_waitcnt vmcnt(10)
    v_perm_b32 v43, v100, v96, s76
    v_perm_b32 v47, v100, v96, s77
    v_perm_b32 v51, v101, v97, s76
    v_perm_b32 v55, v101, v97, s77
    v_perm_b32 v59, v102, v98, s76
    v_perm_b32 v63, v102, v98, s77
    v_perm_b32 v67, v103, v99, s76
    v_perm_b32 v71, v103, v99, s77
    s_cbranch_vccnz L_vt26
    s_waitcnt vmcnt(6)
L_vt26:
    buffer_load_dwordx4 v[144:147], v2, s[36:39], s50 offen nt
    s_add_u32 s50, s50, s73
    s_cbranch_vccnz L_vt27
    s_waitcnt vmcnt(6)
L_vt27:
    buffer_load_dwordx4 v[148:151], v2, s[36:39], s50 offen nt
    s_add_u32 s50, s50, s73
    s_waitcnt vmcnt(10)
    v_perm_b32 v72, v108, v104, s76
    v_perm_b32 v76, v108, v104, s77
    v_perm_b32 v80, v109, v105, s76
    v_perm_b32 v84, v109, v105, s77
    v_perm_b32 v88, v110, v106, s76
    v_perm_b32 v92, v110, v106, s77
    v_perm_b32 v96, v111, v107, s76
    v_perm_b32 v100, v111, v107, s77
    s_cbranch_vccnz L_vt28
    s_waitcnt vmcnt(6)
L_vt28:
    buffer_load_dwordx4 v[152:155], v2, s[36:39], s50 offen nt
    s_add_u32 s50, s50, s73
    s_cbranch_vccnz L_vt29
    s_waitcnt vmcnt(6)
L_vt29:
    buffer_load_dwordx4 v[156:159], v2, s[36:39], s50 offen nt
    s_add_u32 s50, s50, s73
    s_waitcnt vmcnt(10)
    v_perm_b32 v73, v116, v112, s76
    v_perm_b32 v77, v116, v112, s77
    v_perm_b32 v81, v117, v113, s76
    v_perm_b32 v85, v117, v113, s77
    v_perm_b32 v89, v118, v114, s76
    v_perm_b32 v93, v118, v114, s77
    v_perm_b32 v97, v119, v115, s76
    v_perm_b32 v101, v119, v115, s77
    s_cbranch_vccnz L_vt30
    s_waitcnt vmcnt(6)
L_vt30:
    buffer_load_dwordx4 v[160:163], v2, s[36:39], s50 offen nt
    s_add_u32 s50, s50, s73
    s_cbranch_vccnz L_vt31
    s_waitcnt vmcnt(6)
L_vt31:
    buffer_load_dwordx4 v[164:167], v2, s[36:39], s50 offen nt
    s_mov_b64 exec, 1
    ds_add_u32 v255, v254 offset:44
    s_mov_b64 exec, -1
    s_waitcnt vmcnt(10)
    v_perm_b32 v74, v124, v120, s76
    v_perm_b32 v78, v124, v120, s77
    v_perm_b32 v82, v125, v121, s76
    v_perm_b32 v86, v125, v121, s77
    v_perm_b32 v90, v126, v122, s76
    v_perm_b32 v94, v126, v122, s77
    v_perm_b32 v98, v127, v123, s76
    v_perm_b32 v102, v127, v123, s77
    s_waitcnt vmcnt(8)
    v_perm_b32 v75, v132, v128, s76
    v_perm_b32 v79, v132, v128, s77
    v_perm_b32 v83, v133, v129, s76
    v_perm_b32 v87, v133, v129, s77
    v_perm_b32 v91, v134, v130, s76
    v_perm_b32 v95, v134, v130, s77
    v_perm_b32 v99, v135, v131, s76
    v_perm_b32 v103, v135, v131, s77
    s_mov_b32 s78, 0x100000
L_spin17:
    ds_read_b32 v1, v255 offset:8
    s_waitcnt lgkmcnt(0)
    v_readfirstlane_b32 s79, v1
    s_cmp_ge_u32 s79, 2
    s_cbranch_scc1 L_spind18
    s_sleep 1
    s_sub_u32 s78, s78, 1
    s_cbranch_scc0 L_spin17
L_spind18:
    ds_read_b128 v[200:203], v252 offset:0
    ds_read_b128 v[204:207], v252 offset:256
    ds_read_b128 v[208:211], v252 offset:512
    ds_read_b128 v[212:215], v252 offset:768
    s_waitcnt lgkmcnt(0)
    v_mfma_f32_16x16x32_bf16 v[168:171], v[200:203], v[8:11], 0
    v_mfma_f32_16x16x32_bf16 v[172:175], v[200:203], v[12:15], 0
    v_mfma_f32_16x16x32_bf16 v[176:179], v[200:203], v[16:19], 0
    v_mfma_f32_16x16x32_bf16 v[180:183], v[200:203], v[20:23], 0
    v_mfma_f32_16x16x32_bf16 v[184:187], v[200:203], v[24:27], 0
    v_mfma_f32_16x16x32_bf16 v[188:191], v[200:203], v[28:31], 0
    v_mfma_f32_16x16x32_bf16 v[192:195], v[200:203], v[32:35], 0
    v_mfma_f32_16x16x32_bf16 v[196:199], v[200:203], v[36:39], 0
    v_mfma_f32_16x16x32_bf16 v[168:171], v[204:207], v[40:43], v[168:171]
    v_mfma_f32_16x16x32_bf16 v[172:175], v[204:207], v[44:47], v[172:175]
    v_mfma_f32_16x16x32_bf16 v[176:179], v[204:207], v[48:51], v[176:179]
    v_mfma_f32_16x16x32_bf16 v[180:183], v[204:207], v[52:55], v[180:183]
    v_mfma_f32_16x16x32_bf16 v[184:187], v[204:207], v[56:59], v[184:187]
    v_mfma_f32_16x16x32_bf16 v[188:191], v[204:207], v[60:63], v[188:191]
    v_mfma_f32_16x16x32_bf16 v[192:195], v[204:207], v[64:67], v[192:195]
    v_mfma_f32_16x16x32_bf16 v[196:199], v[204:207], v[68:71], v[196:199]
    v_mfma_f32_16x16x32_bf16 v[168:171], v[208:211], v[72:75], v[168:171]
    v_mfma_f32_16x16x32_bf16 v[172:175], v[208:211], v[76:79], v[172:175]
    v_mfma_f32_16x16x32_bf16 v[176:179], v[208:211], v[80:83], v[176:179]
    v_mfma_f32_16x16x32_bf16 v[180:183], v[208:211], v[84:87], v[180:183]
    v_mfma_f32_16x16x32_bf16 v[184:187], v[208:211], v[88:91], v[184:187]
    v_mfma_f32_16x16x32_bf16 v[188:191], v[208:211], v[92:95], v[188:191]
    v_mfma_f32_16x16x32_bf16 v[192:195], v[208:211], v[96:99], v[192:195]
    v_mfma_f32_16x16x32_bf16 v[196:199], v[208:211], v[100:103], v[196:199]
    s_waitcnt vmcnt(6)
    v_perm_b32 v104, v140, v136, s76
    v_perm_b32 v108, v140, v136, s77
    v_perm_b32 v112, v141, v137, s76
    v_perm_b32 v116, v141, v137, s77
    v_perm_b32 v120, v142, v138, s76
    v_perm_b32 v124, v142, v138, s77
    v_perm_b32 v128, v143, v139, s76
    v_perm_b32 v132, v143, v139, s77
    s_waitcnt vmcnt(4)
    v_perm_b32 v105, v148, v144, s76
    v_perm_b32 v109, v148, v144, s77
    v_perm_b32 v113, v149, v145, s76
    v_perm_b32 v117, v149, v145, s77
    v_perm_b32 v121, v150, v146, s76
    v_perm_b32 v125, v150, v146, s77
    v_perm_b32 v129, v151, v147, s76
    v_perm_b32 v133, v151, v147, s77
    s_waitcnt vmcnt(2)
    v_perm_b32 v106, v156, v152, s76
    v_perm_b32 v110, v156, v152, s77
    v_perm_b32 v114, v157, v153, s76
    v_perm_b32 v118, v157, v153, s77
    v_perm_b32 v122, v158, v154, s76
    v_perm_b32 v126, v158, v154, s77
    v_perm_b32 v130, v159, v155, s76
    v_perm_b32 v134, v159, v155, s77
    s_waitcnt vmcnt(0)
    v_perm_b32 v107, v164, v160, s76
    v_perm_b32 v111, v164, v160, s77
    v_perm_b32 v115, v165, v161, s76
    v_mfma_f32_16x16x32_bf16 v[168:171], v[212:215], v[104:107], v[168:171]
    v_perm_b32 v119, v165, v161, s77
    v_mfma_f32_16x16x32_bf16 v[172:175], v[212:215], v[108:111], v[172:175]
    v_perm_b32 v123, v166, v162, s76
    v_mfma_f32_16x16x32_bf16 v[176:179], v[212:215], v[112:115], v[176:179]
    v_perm_b32 v127, v166, v162, s77
    v_mfma_f32_16x16x32_bf16 v[180:183], v[212:215], v[116:119], v[180:183]
    v_perm_b32 v131, v167, v163, s76
    v_mfma_f32_16x16x32_bf16 v[184:187], v[212:215], v[120:123], v[184:187]
    v_perm_b32 v135, v167, v163, s77
    v_mfma_f32_16x16x32_bf16 v[188:191], v[212:215], v[124:127], v[188:191]
    v_add_f32_dpp v216, v169, v168 row_ror:8 row_mask:0xf bank_mask:0x3
    v_mfma_f32_16x16x32_bf16 v[192:195], v[212:215], v[128:131], v[192:195]
    v_add_f32_dpp v217, v173, v172 row_ror:8 row_mask:0xf bank_mask:0x3
    v_mfma_f32_16x16x32_bf16 v[196:199], v[212:215], v[132:135], v[196:199]
    v_add_f32_dpp v216, v176, v177 row_ror:8 row_mask:0xf bank_mask:0xc
    v_add_f32_dpp v217, v180, v181 row_ror:8 row_mask:0xf bank_mask:0xc
    s_mov_b32 exec_hi, 0
    v_add_f32_dpp v218, v185, v184 row_ror:8 row_mask:0xf bank_mask:0x3
    v_cvt_pk_bf16_f32 v220, v216, v217
    ds_write_b32 v253, v220
    v_add_f32_dpp v219, v189, v188 row_ror:8 row_mask:0xf bank_mask:0x3
    v_add_f32_dpp v218, v192, v193 row_ror:8 row_mask:0xf bank_mask:0xc
    s_nop 0
    v_add_f32_dpp v219, v196, v197 row_ror:8 row_mask:0xf bank_mask:0xc
    v_cvt_pk_bf16_f32 v221, v218, v219
    ds_write_b32 v251, v221
    s_cmp_lg_u32 s75, 2
    s_mov_b64 exec, -1
    s_waitcnt lgkmcnt(0)
    s_barrier
    s_cbranch_scc1 L_fin
L_gather:
    ds_read_b32 v38, v255 offset:32
    buffer_load_dwordx4 v[48:51], v240, s[44:47], s64 offen sc1
    buffer_load_dwordx4 v[52:55], v241, s[44:47], s64 offen sc1
    buffer_load_dwordx4 v[56:59], v242, s[44:47], s64 offen sc1
    buffer_load_dwordx4 v[60:63], v243, s[44:47], s64 offen sc1
    v_mov_b32 v16, 0
    v_mov_b32 v17, 0
    v_mov_b32 v18, 0
    v_mov_b32 v19, 0
    v_mov_b32 v20, 0
    v_mov_b32 v21, 0
    v_mov_b32 v22, 0
    v_mov_b32 v23, 0
    s_mov_b64 s[52:53], -1
    s_mov_b64 s[54:55], -1
    s_mov_b64 s[56:57], -1
    s_mov_b64 s[58:59], -1
    s_mov_b32 s78, 65536
    s_movk_i32 s62, 27648
    v_mov_b32 v40, 0
    v_mov_b32 v36, 0x3b124925
    v_mov_b32 v37, 0x3f800054
    v_mov_b32 v39, 0x2edbe6ff
    s_mov_b32 s50, 0xff00ff00
    s_mov_b32 s51, s50
    s_mov_b64 exec, 0xff
    s_lshl_b64 exec, exec, 8
    v_lshlrev_b32 v17, 16, v248
    s_lshl_b64 exec, exec, 8
    v_lshlrev_b32 v18, 16, v248
    s_lshl_b64 exec, exec, 8
    v_lshlrev_b32 v19, 16, v248
    s_lshl_b64 exec, exec, 8
    v_lshlrev_b32 v20, 16, v248
    s_lshl_b64 exec, exec, 8
    v_lshlrev_b32 v21, 16, v248
    s_lshl_b64 exec, exec, 8
    v_lshlrev_b32 v22, 16, v248
    s_lshl_b64 exec, exec, 8
    v_lshlrev_b32 v23, 16, v248
    s_mov_b64 exec, -1
    s_waitcnt lgkmcnt(0)
L_pchk:
    s_or_b64 exec, s[52:53], 1
    buffer_load_dwordx4 v[64:67], v240, s[44:47], s64 offen sc1
    s_mov_b64 exec, s[52:53]
    s_waitcnt vmcnt(4)
    v_cmp_ne_u32_sdwa vcc, v48, v38 src0_sel:WORD_0 src1_sel:WORD_0
    s_wqm_b64 s[52:53], vcc
    s_andn2_b64 exec, exec, s[52:53]
    s_cbranch_scc0 L_pn0_0
    v_and_b32 v48, 0xffff0000, v48
    v_dot2c_f32_bf16 v18, v49, v249
    v_dot2c_f32_bf16 v19, v49, v250
    s_or_b64 s[60:61], s[52:53], s[54:55]
    v_dot2c_f32_bf16 v20, v50, v249
    v_dot2c_f32_bf16 v21, v50, v250
    s_or_b64 s[60:61], s[60:61], s[56:57]
    v_dot2c_f32_bf16 v22, v51, v249
    v_dot2c_f32_bf16 v23, v51, v250
    s_or_b64 s[60:61], s[60:61], s[58:59]
    v_add_f32 v17, v17, v48
    s_cbranch_scc0 L_pok
L_pn0_0:
    s_or_b64 exec, s[54:55], 1
    buffer_load_dwordx4 v[68:71], v241, s[44:47], s64 offen sc1
    s_mov_b64 exec, s[54:55]
    s_waitcnt vmcnt(4)
    v_cmp_ne_u32_sdwa vcc, v52, v38 src0_sel:WORD_0 src1_sel:WORD_0
    s_wqm_b64 s[54:55], vcc
    s_andn2_b64 exec, exec, s[54:55]
    s_cbranch_scc0 L_pn0_1
    v_and_b32 v52, 0xffff0000, v52
    v_dot2c_f32_bf16 v18, v53, v249
    v_dot2c_f32_bf16 v19, v53, v250
    s_or_b64 s[60:61], s[54:55], s[52:53]
    v_dot2c_f32_bf16 v20, v54, v249
    v_dot2c_f32_bf16 v21, v54, v250
    s_or_b64 s[60:61], s[60:61], s[56:57]
    v_dot2c_f32_bf16 v22, v55, v249
    v_dot2c_f32_bf16 v23, v55, v250
    s_or_b64 s[60:61], s[60:61], s[58:59]
    v_add_f32 v17, v17, v52
    s_cbranch_scc0 L_pok
L_pn0_1:
    s_or_b64 exec, s[56:57], 1
    buffer_load_dwordx4 v[72:75], v242, s[44:47], s64 offen sc1
    s_mov_b64 exec, s[56:57]
    s_waitcnt vmcnt(4)
    v_cmp_ne_u32_sdwa vcc, v56, v38 src0_sel:WORD_0 src1_sel:WORD_0
    s_wqm_b64 s[56:57], vcc
    s_andn2_b64 exec, exec, s[56:57]
    s_cbranch_scc0 L_pn0_2
    v_and_b32 v56, 0xffff0000, v56
    v_dot2c_f32_bf16 v18, v57, v249
    v_dot2c_f32_bf16 v19, v57, v250
    s_or_b64 s[60:61], s[56:57], s[52:53]
    v_dot2c_f32_bf16 v20, v58, v249
    v_dot2c_f32_bf16 v21, v58, v250
    s_or_b64 s[60:61], s[60:61], s[54:55]
    v_dot2c_f32_bf16 v22, v59, v249
    v_dot2c_f32_bf16 v23, v59, v250
    s_or_b64 s[60:61], s[60:61], s[58:59]
    v_add_f32 v17, v17, v56
    s_cbranch_scc0 L_pok
L_pn0_2:
    s_or_b64 exec, s[58:59], 1
    buffer_load_dwordx4 v[76:79], v243, s[44:47], s64 offen sc1
    s_mov_b64 exec, s[58:59]
    s_waitcnt vmcnt(4)
    v_cmp_ne_u32_sdwa vcc, v60, v38 src0_sel:WORD_0 src1_sel:WORD_0
    s_wqm_b64 s[58:59], vcc
    s_andn2_b64 exec, exec, s[58:59]
    s_cbranch_scc0 L_pn0_3
    v_and_b32 v60, 0xffff0000, v60
    v_dot2c_f32_bf16 v18, v61, v249
    v_dot2c_f32_bf16 v19, v61, v250
    s_or_b64 s[60:61], s[58:59], s[52:53]
    v_dot2c_f32_bf16 v20, v62, v249
    v_dot2c_f32_bf16 v21, v62, v250
    s_or_b64 s[60:61], s[60:61], s[54:55]
    v_dot2c_f32_bf16 v22, v63, v249
    v_dot2c_f32_bf16 v23, v63, v250
    s_or_b64 s[60:61], s[60:61], s[56:57]
    v_add_f32 v17, v17, v60
    s_cbranch_scc0 L_pok
L_pn0_3:
    s_or_b64 exec, s[52:53], 1
    buffer_load_dwordx4 v[48:51], v240, s[44:47], s64 offen sc1
    s_mov_b64 exec, s[52:53]
    s_waitcnt vmcnt(4)
    v_cmp_ne_u32_sdwa vcc, v64, v38 src0_sel:WORD_0 src1_sel:WORD_0
    s_wqm_b64 s[52:53], vcc
    s_andn2_b64 exec, exec, s[52:53]
    s_cbranch_scc0 L_pn1_0
    v_and_b32 v64, 0xffff0000, v64
    v_dot2c_f32_bf16 v18, v65, v249
    v_dot2c_f32_bf16 v19, v65, v250
    s_or_b64 s[60:61], s[52:53], s[54:55]
    v_dot2c_f32_bf16 v20, v66, v249
    v_dot2c_f32_bf16 v21, v66, v250
    s_or_b64 s[60:61], s[60:61], s[56:57]
    v_dot2c_f32_bf16 v22, v67, v249
    v_dot2c_f32_bf16 v23, v67, v250
    s_or_b64 s[60:61], s[60:61], s[58:59]
    v_add_f32 v17, v17, v64
    s_cbranch_scc0 L_pok
L_pn1_0:
    s_or_b64 exec, s[54:55], 1
    buffer_load_dwordx4 v[52:55], v241, s[44:47], s64 offen sc1
    s_mov_b64 exec, s[54:55]
    s_waitcnt vmcnt(4)
    v_cmp_ne_u32_sdwa vcc, v68, v38 src0_sel:WORD_0 src1_sel:WORD_0
    s_wqm_b64 s[54:55], vcc
    s_andn2_b64 exec, exec, s[54:55]
    s_cbranch_scc0 L_pn1_1
    v_and_b32 v68, 0xffff0000, v68
    v_dot2c_f32_bf16 v18, v69, v249
    v_dot2c_f32_bf16 v19, v69, v250
    s_or_b64 s[60:61], s[54:55], s[52:53]
    v_dot2c_f32_bf16 v20, v70, v249
    v_dot2c_f32_bf16 v21, v70, v250
    s_or_b64 s[60:61], s[60:61], s[56:57]
    v_dot2c_f32_bf16 v22, v71, v249
    v_dot2c_f32_bf16 v23, v71, v250
    s_or_b64 s[60:61], s[60:61], s[58:59]
    v_add_f32 v17, v17, v68
    s_cbranch_scc0 L_pok
L_pn1_1:
    s_or_b64 exec, s[56:57], 1
    buffer_load_dwordx4 v[56:59], v242, s[44:47], s64 offen sc1
    s_mov_b64 exec, s[56:57]
    s_waitcnt vmcnt(4)
    v_cmp_ne_u32_sdwa vcc, v72, v38 src0_sel:WORD_0 src1_sel:WORD_0
    s_wqm_b64 s[56:57], vcc
    s_andn2_b64 exec, exec, s[56:57]
    s_cbranch_scc0 L_pn1_2
    v_and_b32 v72, 0xffff0000, v72
    v_dot2c_f32_bf16 v18, v73, v249
    v_dot2c_f32_bf16 v19, v73, v250
    s_or_b64 s[60:61], s[56:57], s[52:53]
    v_dot2c_f32_bf16 v20, v74, v249
    v_dot2c_f32_bf16 v21, v74, v250
    s_or_b64 s[60:61], s[60:61], s[54:55]
    v_dot2c_f32_bf16 v22, v75, v249
    v_dot2c_f32_bf16 v23, v75, v250
    s_or_b64 s[60:61], s[60:61], s[58:59]
    v_add_f32 v17, v17, v72
    s_cbranch_scc0 L_pok
L_pn1_2:
    s_or_b64 exec, s[58:59], 1
    buffer_load_dwordx4 v[60:63], v243, s[44:47], s64 offen sc1
    s_mov_b64 exec, s[58:59]
    s_waitcnt vmcnt(4)
    v_cmp_ne_u32_sdwa vcc, v76, v38 src0_sel:WORD_0 src1_sel:WORD_0
    s_wqm_b64 s[58:59], vcc
    s_andn2_b64 exec, exec, s[58:59]
    s_cbranch_scc0 L_pn1_3
    v_and_b32 v76, 0xffff0000, v76
    v_dot2c_f32_bf16 v18, v77, v249
    v_dot2c_f32_bf16 v19, v77, v250
    s_or_b64 s[60:61], s[58:59], s[52:53]
    v_dot2c_f32_bf16 v20, v78, v249
    v_dot2c_f32_bf16 v21, v78, v250
    s_or_b64 s[60:61], s[60:61], s[54:55]
    v_dot2c_f32_bf16 v22, v79, v249
    v_dot2c_f32_bf16 v23, v79, v250
    s_or_b64 s[60:61], s[60:61], s[56:57]
    v_add_f32 v17, v17, v76
    s_cbranch_scc0 L_pok
L_pn1_3:
    s_sub_u32 s78, s78, 1
    s_cbranch_scc0 L_pchk
L_pok:
    s_mov_b64 exec, -1
    v_permlane32_swap_b32 v18, v22
    v_permlane32_swap_b32 v19, v23
    v_permlane32_swap_b32 v16, v20
    v_permlane32_swap_b32 v17, v21
    v_pk_add_f32 v[18:19], v[18:19], v[22:23]
    v_pk_add_f32 v[16:17], v[16:17], v[20:21]
    s_nop 1
    v_permlane16_swap_b32 v16, v18
    v_permlane16_swap_b32 v17, v19
    v_pk_add_f32 v[16:17], v[16:17], v[18:19]
    s_nop 1
    v_add_f32_dpp v12, v16, v16 row_ror:8 row_mask:0xf bank_mask:0xf
    v_add_f32_dpp v13, v17, v17 row_ror:8 row_mask:0xf bank_mask:0xf
    v_cndmask_b32 v8, v12, v13, s[50:51]
    v_mul_f32 v11, v12, v12
    v_add_f32 v10, v12, v13
    v_fmac_f32 v11, v13, v13
    s_nop 0
    v_add_f32_dpp v10, v10, v10 row_ror:4 row_mask:0xf bank_mask:0xf
    v_add_f32_dpp v11, v11, v11 row_ror:4 row_mask:0xf bank_mask:0xf
    s_nop 0
    v_add_f32_dpp v10, v10, v10 row_ror:2 row_mask:0xf bank_mask:0xf
    v_add_f32_dpp v11, v11, v11 row_ror:2 row_mask:0xf bank_mask:0xf
    s_nop 0
    v_add_f32_dpp v10, v10, v10 row_ror:1 row_mask:0xf bank_mask:0xf
    v_add_f32_dpp v11, v11, v11 row_ror:1 row_mask:0xf bank_mask:0xf
    s_nop 0
    v_add_f32_dpp v10, v10, v10 row_bcast:15 row_mask:0xa bank_mask:0xf
    v_add_f32_dpp v11, v11, v11 row_bcast:15 row_mask:0xa bank_mask:0xf
    s_nop 0
    v_add_f32_dpp v10, v10, v10 row_bcast:31 row_mask:0xc bank_mask:0xf
    v_add_f32_dpp v11, v11, v11 row_bcast:31 row_mask:0xc bank_mask:0xf
    s_mov_b32 exec_lo, 0
    s_brev_b32 exec_hi, 1
    ds_write_b64 v245, v[10:11]
    s_mov_b64 exec, -1
    s_waitcnt lgkmcnt(0)
    s_barrier
    ds_read_b128 v[16:19], v246 offset:0
    ds_read_b128 v[20:23], v246 offset:16
    ds_read_b128 v[24:27], v246 offset:32
    ds_read_b128 v[28:31], v246 offset:48
    s_waitcnt lgkmcnt(2)
    v_pk_add_f32 v[16:17], v[16:17], v[18:19]
    v_pk_add_f32 v[20:21], v[20:21], v[22:23]
    s_waitcnt lgkmcnt(0)
    v_pk_add_f32 v[24:25], v[24:25], v[26:27]
    v_pk_add_f32 v[28:29], v[28:29], v[30:31]
    v_pk_add_f32 v[16:17], v[16:17], v[20:21]
    v_pk_add_f32 v[24:25], v[24:25], v[28:29]
    v_pk_add_f32 v[16:17], v[16:17], v[24:25]
    v_pk_mul_f32 v[16:17], v[16:17], v[36:37] op_sel_hi:[1,0]
    v_fma_f32 v17, -v16, v16, v17
    v_max_f32 v17, 0, v17
    v_fma_f32 v17, v17, v37, v39
    v_rsq_f32 v17, v17
    v_sub_f32 v16, v8, v16
    v_mul_f32 v16, v16, v17
    v_cvt_pk_bf16_f32 v24, v16, 0
    v_lshlrev_b32 v16, 1, v24
    ds_read_u16_d16_hi v40, v16
    s_movk_i32 exec_lo, 0xff00
    v_subrev_u32_sdwa v16, s62, v16 dst_sel:DWORD dst_unused:UNUSED_PAD src0_sel:DWORD src1_sel:WORD_0
    v_cmp_le_u32 vcc, 6144, v16
    s_cbranch_vccnz L_fallback
L_fbret:
    s_waitcnt lgkmcnt(0)
    v_add_f32 v8, v8, v40
    v_cvt_pk_bf16_f32 v8, v8, v8
    global_store_short v247, v8, s[24:25]
    s_cmp_lg_u32 s65, 0
    s_cbranch_scc1 L_noe
    s_mov_b64 exec, 1
    buffer_store_dword v38, off, s[44:47], 0 offset:0
L_noe:
L_fin:
L_end:
    s_endpgm
L_code_end:
L_fallback:
    s_mov_b64 s[72:73], vcc
    s_mov_b64 exec, -1
    s_load_dword s67, s[22:23], 0
    v_lshlrev_b32 v2, 2, v0
    global_load_dword v48, v2, s[16:17] offset:0
    global_load_dword v49, v2, s[16:17] offset:256
    global_load_dword v50, v2, s[16:17] offset:512
    global_load_dword v51, v2, s[16:17] offset:768
    global_load_dword v52, v2, s[16:17] offset:1024
    global_load_dword v53, v2, s[16:17] offset:1280
    global_load_dword v54, v2, s[16:17] offset:1536
    global_load_dword v55, v2, s[16:17] offset:1792
    global_load_dword v56, v2, s[16:17] offset:2048
    global_load_dword v57, v2, s[16:17] offset:2304
    global_load_dword v58, v2, s[16:17] offset:2560
    global_load_dword v59, v2, s[16:17] offset:2816
    global_load_dword v60, v2, s[16:17] offset:3072
    global_load_dword v61, v2, s[16:17] offset:3328
    global_load_dword v62, v2, s[18:19] offset:0
    global_load_dword v63, v2, s[18:19] offset:256
    global_load_dword v64, v2, s[18:19] offset:512
    global_load_dword v65, v2, s[18:19] offset:768
    global_load_dword v66, v2, s[18:19] offset:1024
    global_load_dword v67, v2, s[18:19] offset:1280
    global_load_dword v68, v2, s[18:19] offset:1536
    global_load_dword v69, v2, s[18:19] offset:1792
    global_load_dword v70, v2, s[18:19] offset:2048
    global_load_dword v71, v2, s[18:19] offset:2304
    global_load_dword v72, v2, s[18:19] offset:2560
    global_load_dword v73, v2, s[18:19] offset:2816
    global_load_dword v74, v2, s[18:19] offset:3072
    global_load_dword v75, v2, s[18:19] offset:3328
    global_load_dword v76, v2, s[20:21] offset:0
    global_load_dword v77, v2, s[20:21] offset:256
    global_load_dword v78, v2, s[20:21] offset:512
    global_load_dword v79, v2, s[20:21] offset:768
    global_load_dword v80, v2, s[20:21] offset:1024
    global_load_dword v81, v2, s[20:21] offset:1280
    global_load_dword v82, v2, s[20:21] offset:1536
    global_load_dword v83, v2, s[20:21] offset:1792
    global_load_dword v84, v2, s[20:21] offset:2048
    global_load_dword v85, v2, s[20:21] offset:2304
    global_load_dword v86, v2, s[20:21] offset:2560
    global_load_dword v87, v2, s[20:21] offset:2816
    global_load_dword v88, v2, s[20:21] offset:3072
    global_load_dword v89, v2, s[20:21] offset:3328
    v_mov_b32 v92, 0xbdd2d3e8
    v_mov_b32 v93, 0xc0135761
    v_lshlrev_b32 v24, 16, v24
    s_waitcnt vmcnt(0) lgkmcnt(0)
    s_lshl_b32 s67, s67, 16
    v_lshlrev_b32 v104, 16, v48
    v_and_b32 v105, 0xffff0000, v48
    v_lshlrev_b32 v106, 16, v49
    v_and_b32 v107, 0xffff0000, v49
    v_lshlrev_b32 v108, 16, v50
    v_and_b32 v109, 0xffff0000, v50
    v_lshlrev_b32 v110, 16, v51
    v_and_b32 v111, 0xffff0000, v51
    v_lshlrev_b32 v112, 16, v52
    v_and_b32 v113, 0xffff0000, v52
    v_lshlrev_b32 v114, 16, v53
    v_and_b32 v115, 0xffff0000, v53
    v_lshlrev_b32 v116, 16, v54
    v_and_b32 v117, 0xffff0000, v54
    v_lshlrev_b32 v118, 16, v55
    v_and_b32 v119, 0xffff0000, v55
    v_lshlrev_b32 v120, 16, v56
    v_and_b32 v121, 0xffff0000, v56
    v_lshlrev_b32 v122, 16, v57
    v_and_b32 v123, 0xffff0000, v57
    v_lshlrev_b32 v124, 16, v58
    v_and_b32 v125, 0xffff0000, v58
    v_lshlrev_b32 v126, 16, v59
    v_and_b32 v127, 0xffff0000, v59
    v_lshlrev_b32 v128, 16, v60
    v_and_b32 v129, 0xffff0000, v60
    v_lshlrev_b32 v130, 16, v61
    v_and_b32 v131, 0xffff0000, v61
    v_lshlrev_b32 v132, 16, v62
    v_and_b32 v133, 0xffff0000, v62
    v_lshlrev_b32 v134, 16, v63
    v_and_b32 v135, 0xffff0000, v63
    v_lshlrev_b32 v136, 16, v64
    v_and_b32 v137, 0xffff0000, v64
    v_lshlrev_b32 v138, 16, v65
    v_and_b32 v139, 0xffff0000, v65
    v_lshlrev_b32 v140, 16, v66
    v_and_b32 v141, 0xffff0000, v66
    v_lshlrev_b32 v142, 16, v67
    v_and_b32 v143, 0xffff0000, v67
    v_lshlrev_b32 v144, 16, v68
    v_and_b32 v145, 0xffff0000, v68
    v_lshlrev_b32 v146, 16, v69
    v_and_b32 v147, 0xffff0000, v69
    v_lshlrev_b32 v148, 16, v70
    v_and_b32 v149, 0xffff0000, v70
    v_lshlrev_b32 v150, 16, v71
    v_and_b32 v151, 0xffff0000, v71
    v_lshlrev_b32 v152, 16, v72
    v_and_b32 v153, 0xffff0000, v72
    v_lshlrev_b32 v154, 16, v73
    v_and_b32 v155, 0xffff0000, v73
    v_lshlrev_b32 v156, 16, v74
    v_and_b32 v157, 0xffff0000, v74
    v_lshlrev_b32 v158, 16, v75
    v_and_b32 v159, 0xffff0000, v75
    v_lshlrev_b32 v160, 16, v76
    v_and_b32 v161, 0xffff0000, v76
    v_lshlrev_b32 v162, 16, v77
    v_and_b32 v163, 0xffff0000, v77
    v_lshlrev_b32 v164, 16, v78
    v_and_b32 v165, 0xffff0000, v78
    v_lshlrev_b32 v166, 16, v79
    v_and_b32 v167, 0xffff0000, v79
    v_lshlrev_b32 v168, 16, v80
    v_and_b32 v169, 0xffff0000, v80
    v_lshlrev_b32 v170, 16, v81
    v_and_b32 v171, 0xffff0000, v81
    v_lshlrev_b32 v172, 16, v82
    v_and_b32 v173, 0xffff0000, v82
    v_lshlrev_b32 v174, 16, v83
    v_and_b32 v175, 0xffff0000, v83
    v_lshlrev_b32 v176, 16, v84
    v_and_b32 v177, 0xffff0000, v84
    v_lshlrev_b32 v178, 16, v85
    v_and_b32 v179, 0xffff0000, v85
    v_lshlrev_b32 v180, 16, v86
    v_and_b32 v181, 0xffff0000, v86
    v_lshlrev_b32 v182, 16, v87
    v_and_b32 v183, 0xffff0000, v87
    v_lshlrev_b32 v184, 16, v88
    v_and_b32 v185, 0xffff0000, v88
    v_lshlrev_b32 v186, 16, v89
    v_and_b32 v187, 0xffff0000, v89
L_fbl:
    s_ff1_i32_b64 s53, s[72:73]
    s_bitset0_b64 s[72:73], s53
    v_readlane_b32 s60, v24, s53
    v_mov_b32 v94, 0
    v_mov_b32 v95, 0
    v_pk_fma_f32 v[96:97], v[104:105], s[60:61], v[132:133] op_sel_hi:[1,0,1]
    v_pk_mul_f32 v[98:99], v[96:97], v[96:97]
    v_pk_fma_f32 v[98:99], v[98:99], v[92:93], v[92:93] op_sel:[0,0,1] op_sel_hi:[1,0,1]
    v_pk_mul_f32 v[98:99], v[98:99], v[96:97]
    v_exp_f32 v98, v98
    v_exp_f32 v99, v99
    v_pk_mul_f32 v[96:97], v[96:97], v[160:161]
    v_pk_add_f32 v[98:99], v[98:99], 1.0 op_sel_hi:[1,0]
    v_rcp_f32 v98, v98
    v_rcp_f32 v99, v99
    s_nop 0
    v_pk_fma_f32 v[94:95], v[96:97], v[98:99], v[94:95]
    v_pk_fma_f32 v[96:97], v[106:107], s[60:61], v[134:135] op_sel_hi:[1,0,1]
    v_pk_mul_f32 v[98:99], v[96:97], v[96:97]
    v_pk_fma_f32 v[98:99], v[98:99], v[92:93], v[92:93] op_sel:[0,0,1] op_sel_hi:[1,0,1]
    v_pk_mul_f32 v[98:99], v[98:99], v[96:97]
    v_exp_f32 v98, v98
    v_exp_f32 v99, v99
    v_pk_mul_f32 v[96:97], v[96:97], v[162:163]
    v_pk_add_f32 v[98:99], v[98:99], 1.0 op_sel_hi:[1,0]
    v_rcp_f32 v98, v98
    v_rcp_f32 v99, v99
    s_nop 0
    v_pk_fma_f32 v[94:95], v[96:97], v[98:99], v[94:95]
    v_pk_fma_f32 v[96:97], v[108:109], s[60:61], v[136:137] op_sel_hi:[1,0,1]
    v_pk_mul_f32 v[98:99], v[96:97], v[96:97]
    v_pk_fma_f32 v[98:99], v[98:99], v[92:93], v[92:93] op_sel:[0,0,1] op_sel_hi:[1,0,1]
    v_pk_mul_f32 v[98:99], v[98:99], v[96:97]
    v_exp_f32 v98, v98
    v_exp_f32 v99, v99
    v_pk_mul_f32 v[96:97], v[96:97], v[164:165]
    v_pk_add_f32 v[98:99], v[98:99], 1.0 op_sel_hi:[1,0]
    v_rcp_f32 v98, v98
    v_rcp_f32 v99, v99
    s_nop 0
    v_pk_fma_f32 v[94:95], v[96:97], v[98:99], v[94:95]
    v_pk_fma_f32 v[96:97], v[110:111], s[60:61], v[138:139] op_sel_hi:[1,0,1]
    v_pk_mul_f32 v[98:99], v[96:97], v[96:97]
    v_pk_fma_f32 v[98:99], v[98:99], v[92:93], v[92:93] op_sel:[0,0,1] op_sel_hi:[1,0,1]
    v_pk_mul_f32 v[98:99], v[98:99], v[96:97]
    v_exp_f32 v98, v98
    v_exp_f32 v99, v99
    v_pk_mul_f32 v[96:97], v[96:97], v[166:167]
    v_pk_add_f32 v[98:99], v[98:99], 1.0 op_sel_hi:[1,0]
    v_rcp_f32 v98, v98
    v_rcp_f32 v99, v99
    s_nop 0
    v_pk_fma_f32 v[94:95], v[96:97], v[98:99], v[94:95]
    v_pk_fma_f32 v[96:97], v[112:113], s[60:61], v[140:141] op_sel_hi:[1,0,1]
    v_pk_mul_f32 v[98:99], v[96:97], v[96:97]
    v_pk_fma_f32 v[98:99], v[98:99], v[92:93], v[92:93] op_sel:[0,0,1] op_sel_hi:[1,0,1]
    v_pk_mul_f32 v[98:99], v[98:99], v[96:97]
    v_exp_f32 v98, v98
    v_exp_f32 v99, v99
    v_pk_mul_f32 v[96:97], v[96:97], v[168:169]
    v_pk_add_f32 v[98:99], v[98:99], 1.0 op_sel_hi:[1,0]
    v_rcp_f32 v98, v98
    v_rcp_f32 v99, v99
    s_nop 0
    v_pk_fma_f32 v[94:95], v[96:97], v[98:99], v[94:95]
    v_pk_fma_f32 v[96:97], v[114:115], s[60:61], v[142:143] op_sel_hi:[1,0,1]
    v_pk_mul_f32 v[98:99], v[96:97], v[96:97]
    v_pk_fma_f32 v[98:99], v[98:99], v[92:93], v[92:93] op_sel:[0,0,1] op_sel_hi:[1,0,1]
    v_pk_mul_f32 v[98:99], v[98:99], v[96:97]
    v_exp_f32 v98, v98
    v_exp_f32 v99, v99
    v_pk_mul_f32 v[96:97], v[96:97], v[170:171]
    v_pk_add_f32 v[98:99], v[98:99], 1.0 op_sel_hi:[1,0]
    v_rcp_f32 v98, v98
    v_rcp_f32 v99, v99
    s_nop 0
    v_pk_fma_f32 v[94:95], v[96:97], v[98:99], v[94:95]
    v_pk_fma_f32 v[96:97], v[116:117], s[60:61], v[144:145] op_sel_hi:[1,0,1]
    v_pk_mul_f32 v[98:99], v[96:97], v[96:97]
    v_pk_fma_f32 v[98:99], v[98:99], v[92:93], v[92:93] op_sel:[0,0,1] op_sel_hi:[1,0,1]
    v_pk_mul_f32 v[98:99], v[98:99], v[96:97]
    v_exp_f32 v98, v98
    v_exp_f32 v99, v99
    v_pk_mul_f32 v[96:97], v[96:97], v[172:173]
    v_pk_add_f32 v[98:99], v[98:99], 1.0 op_sel_hi:[1,0]
    v_rcp_f32 v98, v98
    v_rcp_f32 v99, v99
    s_nop 0
    v_pk_fma_f32 v[94:95], v[96:97], v[98:99], v[94:95]
    v_pk_fma_f32 v[96:97], v[118:119], s[60:61], v[146:147] op_sel_hi:[1,0,1]
    v_pk_mul_f32 v[98:99], v[96:97], v[96:97]
    v_pk_fma_f32 v[98:99], v[98:99], v[92:93], v[92:93] op_sel:[0,0,1] op_sel_hi:[1,0,1]
    v_pk_mul_f32 v[98:99], v[98:99], v[96:97]
    v_exp_f32 v98, v98
    v_exp_f32 v99, v99
    v_pk_mul_f32 v[96:97], v[96:97], v[174:175]
    v_pk_add_f32 v[98:99], v[98:99], 1.0 op_sel_hi:[1,0]
    v_rcp_f32 v98, v98
    v_rcp_f32 v99, v99
    s_nop 0
    v_pk_fma_f32 v[94:95], v[96:97], v[98:99], v[94:95]
    v_pk_fma_f32 v[96:97], v[120:121], s[60:61], v[148:149] op_sel_hi:[1,0,1]
    v_pk_mul_f32 v[98:99], v[96:97], v[96:97]
    v_pk_fma_f32 v[98:99], v[98:99], v[92:93], v[92:93] op_sel:[0,0,1] op_sel_hi:[1,0,1]
    v_pk_mul_f32 v[98:99], v[98:99], v[96:97]
    v_exp_f32 v98, v98
    v_exp_f32 v99, v99
    v_pk_mul_f32 v[96:97], v[96:97], v[176:177]
    v_pk_add_f32 v[98:99], v[98:99], 1.0 op_sel_hi:[1,0]
    v_rcp_f32 v98, v98
    v_rcp_f32 v99, v99
    s_nop 0
    v_pk_fma_f32 v[94:95], v[96:97], v[98:99], v[94:95]
    v_pk_fma_f32 v[96:97], v[122:123], s[60:61], v[150:151] op_sel_hi:[1,0,1]
    v_pk_mul_f32 v[98:99], v[96:97], v[96:97]
    v_pk_fma_f32 v[98:99], v[98:99], v[92:93], v[92:93] op_sel:[0,0,1] op_sel_hi:[1,0,1]
    v_pk_mul_f32 v[98:99], v[98:99], v[96:97]
    v_exp_f32 v98, v98
    v_exp_f32 v99, v99
    v_pk_mul_f32 v[96:97], v[96:97], v[178:179]
    v_pk_add_f32 v[98:99], v[98:99], 1.0 op_sel_hi:[1,0]
    v_rcp_f32 v98, v98
    v_rcp_f32 v99, v99
    s_nop 0
    v_pk_fma_f32 v[94:95], v[96:97], v[98:99], v[94:95]
    v_pk_fma_f32 v[96:97], v[124:125], s[60:61], v[152:153] op_sel_hi:[1,0,1]
    v_pk_mul_f32 v[98:99], v[96:97], v[96:97]
    v_pk_fma_f32 v[98:99], v[98:99], v[92:93], v[92:93] op_sel:[0,0,1] op_sel_hi:[1,0,1]
    v_pk_mul_f32 v[98:99], v[98:99], v[96:97]
    v_exp_f32 v98, v98
    v_exp_f32 v99, v99
    v_pk_mul_f32 v[96:97], v[96:97], v[180:181]
    v_pk_add_f32 v[98:99], v[98:99], 1.0 op_sel_hi:[1,0]
    v_rcp_f32 v98, v98
    v_rcp_f32 v99, v99
    s_nop 0
    v_pk_fma_f32 v[94:95], v[96:97], v[98:99], v[94:95]
    v_pk_fma_f32 v[96:97], v[126:127], s[60:61], v[154:155] op_sel_hi:[1,0,1]
    v_pk_mul_f32 v[98:99], v[96:97], v[96:97]
    v_pk_fma_f32 v[98:99], v[98:99], v[92:93], v[92:93] op_sel:[0,0,1] op_sel_hi:[1,0,1]
    v_pk_mul_f32 v[98:99], v[98:99], v[96:97]
    v_exp_f32 v98, v98
    v_exp_f32 v99, v99
    v_pk_mul_f32 v[96:97], v[96:97], v[182:183]
    v_pk_add_f32 v[98:99], v[98:99], 1.0 op_sel_hi:[1,0]
    v_rcp_f32 v98, v98
    v_rcp_f32 v99, v99
    s_nop 0
    v_pk_fma_f32 v[94:95], v[96:97], v[98:99], v[94:95]
    v_pk_fma_f32 v[96:97], v[128:129], s[60:61], v[156:157] op_sel_hi:[1,0,1]
    v_pk_mul_f32 v[98:99], v[96:97], v[96:97]
    v_pk_fma_f32 v[98:99], v[98:99], v[92:93], v[92:93] op_sel:[0,0,1] op_sel_hi:[1,0,1]
    v_pk_mul_f32 v[98:99], v[98:99], v[96:97]
    v_exp_f32 v98, v98
    v_exp_f32 v99, v99
    v_pk_mul_f32 v[96:97], v[96:97], v[184:185]
    v_pk_add_f32 v[98:99], v[98:99], 1.0 op_sel_hi:[1,0]
    v_rcp_f32 v98, v98
    v_rcp_f32 v99, v99
    s_nop 0
    v_pk_fma_f32 v[94:95], v[96:97], v[98:99], v[94:95]
    v_pk_fma_f32 v[96:97], v[130:131], s[60:61], v[158:159] op_sel_hi:[1,0,1]
    v_pk_mul_f32 v[98:99], v[96:97], v[96:97]
    v_pk_fma_f32 v[98:99], v[98:99], v[92:93], v[92:93] op_sel:[0,0,1] op_sel_hi:[1,0,1]
    v_pk_mul_f32 v[98:99], v[98:99], v[96:97]
    v_exp_f32 v98, v98
    v_exp_f32 v99, v99
    v_pk_mul_f32 v[96:97], v[96:97], v[186:187]
    v_pk_add_f32 v[98:99], v[98:99], 1.0 op_sel_hi:[1,0]
    v_rcp_f32 v98, v98
    v_rcp_f32 v99, v99
    s_nop 0
    v_pk_fma_f32 v[94:95], v[96:97], v[98:99], v[94:95]
    v_add_f32 v94, v94, v95
    s_nop 1
    v_add_f32_dpp v94, v94, v94 row_ror:8 row_mask:0xf bank_mask:0xf
    s_nop 1
    v_add_f32_dpp v94, v94, v94 row_ror:4 row_mask:0xf bank_mask:0xf
    s_nop 1
    v_add_f32_dpp v94, v94, v94 row_ror:2 row_mask:0xf bank_mask:0xf
    s_nop 1
    v_add_f32_dpp v94, v94, v94 row_ror:1 row_mask:0xf bank_mask:0xf
    s_nop 1
    v_add_f32_dpp v94, v94, v94 row_bcast:15 row_mask:0xa bank_mask:0xf
    s_nop 1
    v_add_f32_dpp v94, v94, v94 row_bcast:31 row_mask:0xc bank_mask:0xf
    v_add_f32 v94, s67, v94
    s_mov_b32 m0, s53
    v_readlane_b32 s60, v94, 63
    s_nop 3
    v_writelane_b32 v40, s60, m0
    s_cmp_lg_u64 s[72:73], 0
    s_cbranch_scc1 L_fbl
    s_movk_i32 exec_lo, 0xff00
    s_branch L_fbret
.section .rodata,"a"
.p2align 6
.amdhsa_kernel sequential_preLN__sliding_block_cached__mixer_token_mlp__decode_kernel
.amdhsa_next_free_vgpr 256
.amdhsa_next_free_sgpr 102
.amdhsa_accum_offset 256
.amdhsa_group_segment_fixed_size 0
.amdhsa_kernarg_size 104
.amdhsa_user_sgpr_count 2
.amdhsa_user_sgpr_kernarg_segment_ptr 1
.amdhsa_system_sgpr_workgroup_id_x 1
.amdhsa_float_denorm_mode_32 3
.end_amdhsa_kernel
```
